```python
import torch

def _softmax(x, axis=-1):
    return torch.softmax(x, dim=axis)
def _gelu(x):
    return torch.nn.functional.gelu(x, approximate="tanh")
def _silu(x):
    return torch.nn.functional.silu(x)
def _sigmoid(x):
    return torch.sigmoid(x)
def _layernorm(x, axis=-1, eps=1e-5):
    m = x.mean(dim=axis, keepdim=True)
    v = x.var(dim=axis, keepdim=True, unbiased=False)
    return (x - m) / torch.sqrt(v + eps)
def _scatter_add(tgt, idx, src, axis=0):
    return tgt.clone().index_add_(axis, idx, src)
def _segment_sum(src, seg, n):
    out = torch.zeros((n,) + src.shape[1:], dtype=src.dtype)
    return out.index_add_(0, seg, src)
def _pad(x, pw):
    flat = tuple(v for pair in reversed(pw) for v in pair)
    return torch.nn.functional.pad(x, flat)

kernel_name = 'concat_heads__mha_block__spectral_gfnet__prompt'

def setup_inputs():

    _w = (lambda a: (lambda t: t.to(torch.bfloat16) if t.is_floating_point() else t)(torch.as_tensor(a)))
    def _A_setup():
        B, S, D, H = 1, 2048, 512, 32
        return {
            "x": _w((lambda *s: torch.randn(*s, dtype=torch.bfloat16) * 0.2)(B, S, D)),
            "wqkv": _w((lambda *s: torch.randn(*s, dtype=torch.bfloat16) * 0.2)(D, 3 * D)),
            "wo": _w((lambda *s: torch.randn(*s, dtype=torch.bfloat16) * 0.05)(D, D)),
        }
    _A_in = _A_setup()

    def _B_setup():
        B, S, D = 1, 2048, 512
        Df = D // 2 + 1
        return {
            "x": _w((lambda *s: torch.randn(*s, dtype=torch.bfloat16) * 0.05)(B, S, D)),
            "w_r": _w((lambda *s: torch.randn(*s, dtype=torch.bfloat16) * 6.4)(S, Df) * 0.02),
            "w_i": _w((lambda *s: torch.randn(*s, dtype=torch.bfloat16) * 6.4)(S, Df) * 0.02),
        }
    _B_in = _B_setup()

    return {
        "A_x": _A_in["x"],
        "A_wqkv": _A_in["wqkv"],
        "A_wo": _A_in["wo"],
        "B_x": _B_in["x"],
        "B_w_r": _B_in["w_r"],
        "B_w_i": _B_in["w_i"],
    }

def reference(A_x, A_wqkv, A_wo, B_x, B_w_r, B_w_i):
    def _A_ref(x, wqkv, wo):
        B, S, D = x.shape
        H = 32
        Dh = D // H
        qkv = (lambda x, *d: x.permute(*d))((x @ wqkv).reshape(B, S, 3, H, Dh), 2, 0, 3, 1, 4)
        q, k, v = qkv[0], qkv[1], qkv[2]
        scores = torch.einsum("bhqd,bhkd->bhqk", q, k) * (Dh ** -0.5)
        p = _softmax(scores, axis=-1)
        o = torch.einsum("bhqk,bhkd->bhqd", p, v)
        return (lambda x, *d: x.permute(*d))(o, 0, 2, 1, 3).reshape(B, S, D) @ wo

    def _B_ref(x, w_r, w_i):
        B, S, D = x.shape
        X = (lambda x, axes=(-2,-1): torch.fft.rfft2(x.float(), dim=axes))(x, axes=(-2, -1))
        W = w_r + 1j * w_i
        X = X * W
        y = (lambda x, s, axes=(-2,-1): torch.fft.irfft2(x, s=s, dim=axes).to(torch.bfloat16))(X, (S, D), axes=(-2, -1))
        return y

    a = _A_ref(A_x, A_wqkv, A_wo)
    b = _B_ref(B_x, B_w_r, B_w_i)
    return torch.concatenate([a, b], axis=-1)
```

```asm
; @launch kernel=qkv_rowfft_kernel grid=(256,1,1) block=(512,1,1) lds=133120
; @launch kernel=attn_proj_kernel grid=(256,1,1) block=(768,1,1) lds=163840
.amdgcn_target "amdgcn-amd-amdhsa--gfx950"
.text
.globl qkv_rowfft_kernel
.p2align 8
.type qkv_rowfft_kernel,@function
qkv_rowfft_kernel:
    s_cmp_ge_u32 s2, 256
    s_cbranch_scc1 k1_end
    s_load_dwordx4 s[4:7], s[0:1], 0
    s_load_dwordx2 s[8:9], s[0:1], 16
    s_load_dwordx2 s[10:11], s[0:1], 24
    s_load_dwordx4 s[12:15], s[0:1], 32
    s_load_dwordx2 s[16:17], s[0:1], 64
    v_and_b32 v1, 63, v0
    v_lshrrev_b32 v2, 6, v0
    s_nop 0
    v_readfirstlane_b32 s3, v2
    s_cmp_ge_u32 s2, 192
    s_cbranch_scc1 k1_B
    s_and_b32 s18, s2, 7
    s_lshr_b32 s19, s2, 3
    s_and_b32 s28, s18, 3
    s_lshl_b32 s28, s28, 2
    s_and_b32 s29, s19, 3
    s_add_u32 s28, s28, s29
    s_lshr_b32 s29, s18, 2
    s_mul_i32 s29, s29, 6
    s_lshr_b32 s30, s19, 2
    s_add_u32 s29, s29, s30
    s_cmp_ge_u32 s3, 4
    s_cbranch_scc0 k1_compute
    s_sub_u32 s30, s3, 4
    v_lshrrev_b32 v2, 3, v1
    v_lshrrev_b32 v3, 4, v1
    v_and_b32 v4, 7, v1
    v_xor_b32 v4, v4, v3
    v_lshlrev_b32 v4, 4, v4
    v_lshl_add_u32 v4, v2, 10, v4
    v_xor_b32 v5, 64, v4
    v_and_b32 v6, 15, v1
    v_lshlrev_b32 v7, 2, v3
    v_xor_b32 v6, v6, v7
    v_lshlrev_b32 v6, 4, v6
    v_mul_u32_u24 v7, 3072, v3
    v_add_u32 v6, v6, v7
    s_lshl_b32 s31, s28, 17
    s_lshl_b32 s32, s30, 15
    s_add_u32 s31, s31, s32
    s_mul_i32 s32, s30, 16*3072
    s_lshl_b32 s33, s29, 8
    s_add_u32 s32, s32, s33
    s_lshl_b32 s33, s30, 12
    s_waitcnt lgkmcnt(0)
    s_mov_b32 s20, s4
    s_and_b32 s21, s5, 0xffff
    s_mov_b32 s22, 2097152
    s_mov_b32 s23, 0x20000
    s_mov_b32 s24, s6
    s_and_b32 s25, s7, 0xffff
    s_mov_b32 s26, 1572864
    s_mov_b32 s27, 0x20000
    s_lshr_b32 s35, s19, 2
    s_and_b32 s36, s19, 3
    s_lshl_b32 s36, s36, 1
    s_add_u32 s35, s35, s36
    s_lshr_b32 s35, s19, 2
    s_and_b32 s36, s19, 3
    s_add_u32 s36, s36, s35
    s_and_b32 s36, s36, 3
    s_lshl_b32 s36, s36, 1
    s_lshr_b32 s35, s35, 2
    s_add_u32 s35, s35, s36
    s_add_u32 s36, s35, 0
    s_and_b32 s36, s36, 7
    s_lshl_b32 s37, s36, 7
    s_add_u32 s37, s37, s31
    s_mul_i32 s38, s36, 196608
    s_add_u32 s38, s38, s32
    s_add_u32 m0, s33, 0
    s_add_u32 s34, s37, 0
    buffer_load_dwordx4 v4, s[20:23], s34 offen lds
    s_add_u32 m0, s33, 1024
    s_add_u32 s34, s37, 8192
    buffer_load_dwordx4 v5, s[20:23], s34 offen lds
    s_add_u32 m0, s33, 2048
    s_add_u32 s34, s37, 16384
    buffer_load_dwordx4 v4, s[20:23], s34 offen lds
    s_add_u32 m0, s33, 3072
    s_add_u32 s34, s37, 24576
    buffer_load_dwordx4 v5, s[20:23], s34 offen lds
    s_add_u32 m0, s33, 16384
    s_add_u32 s34, s38, 0
    buffer_load_dwordx4 v6, s[24:27], s34 offen lds
    s_add_u32 m0, s33, 17408
    s_add_u32 s34, s38, 12288
    buffer_load_dwordx4 v6, s[24:27], s34 offen lds
    s_add_u32 m0, s33, 18432
    s_add_u32 s34, s38, 24576
    buffer_load_dwordx4 v6, s[24:27], s34 offen lds
    s_add_u32 m0, s33, 19456
    s_add_u32 s34, s38, 36864
    buffer_load_dwordx4 v6, s[24:27], s34 offen lds
    s_add_u32 s36, s35, 1
    s_and_b32 s36, s36, 7
    s_lshl_b32 s37, s36, 7
    s_add_u32 s37, s37, s31
    s_mul_i32 s38, s36, 196608
    s_add_u32 s38, s38, s32
    s_add_u32 m0, s33, 32768
    s_add_u32 s34, s37, 0
    buffer_load_dwordx4 v4, s[20:23], s34 offen lds
    s_add_u32 m0, s33, 33792
    s_add_u32 s34, s37, 8192
    buffer_load_dwordx4 v5, s[20:23], s34 offen lds
    s_add_u32 m0, s33, 34816
    s_add_u32 s34, s37, 16384
    buffer_load_dwordx4 v4, s[20:23], s34 offen lds
    s_add_u32 m0, s33, 35840
    s_add_u32 s34, s37, 24576
    buffer_load_dwordx4 v5, s[20:23], s34 offen lds
    s_add_u32 m0, s33, 49152
    s_add_u32 s34, s38, 0
    buffer_load_dwordx4 v6, s[24:27], s34 offen lds
    s_add_u32 m0, s33, 50176
    s_add_u32 s34, s38, 12288
    buffer_load_dwordx4 v6, s[24:27], s34 offen lds
    s_add_u32 m0, s33, 51200
    s_add_u32 s34, s38, 24576
    buffer_load_dwordx4 v6, s[24:27], s34 offen lds
    s_add_u32 m0, s33, 52224
    s_add_u32 s34, s38, 36864
    buffer_load_dwordx4 v6, s[24:27], s34 offen lds
    s_waitcnt vmcnt(8)
    s_barrier
    s_add_u32 s36, s35, 2
    s_and_b32 s36, s36, 7
    s_lshl_b32 s37, s36, 7
    s_add_u32 s37, s37, s31
    s_mul_i32 s38, s36, 196608
    s_add_u32 s38, s38, s32
    s_add_u32 m0, s33, 65536
    s_add_u32 s34, s37, 0
    buffer_load_dwordx4 v4, s[20:23], s34 offen lds
    s_add_u32 m0, s33, 66560
    s_add_u32 s34, s37, 8192
    buffer_load_dwordx4 v5, s[20:23], s34 offen lds
    s_add_u32 m0, s33, 67584
    s_add_u32 s34, s37, 16384
    buffer_load_dwordx4 v4, s[20:23], s34 offen lds
    s_add_u32 m0, s33, 68608
    s_add_u32 s34, s37, 24576
    buffer_load_dwordx4 v5, s[20:23], s34 offen lds
    s_add_u32 m0, s33, 81920
    s_add_u32 s34, s38, 0
    buffer_load_dwordx4 v6, s[24:27], s34 offen lds
    s_add_u32 m0, s33, 82944
    s_add_u32 s34, s38, 12288
    buffer_load_dwordx4 v6, s[24:27], s34 offen lds
    s_add_u32 m0, s33, 83968
    s_add_u32 s34, s38, 24576
    buffer_load_dwordx4 v6, s[24:27], s34 offen lds
    s_add_u32 m0, s33, 84992
    s_add_u32 s34, s38, 36864
    buffer_load_dwordx4 v6, s[24:27], s34 offen lds
    s_waitcnt vmcnt(8)
    s_barrier
    s_add_u32 s36, s35, 3
    s_and_b32 s36, s36, 7
    s_lshl_b32 s37, s36, 7
    s_add_u32 s37, s37, s31
    s_mul_i32 s38, s36, 196608
    s_add_u32 s38, s38, s32
    s_add_u32 m0, s33, 98304
    s_add_u32 s34, s37, 0
    buffer_load_dwordx4 v4, s[20:23], s34 offen lds
    s_add_u32 m0, s33, 99328
    s_add_u32 s34, s37, 8192
    buffer_load_dwordx4 v5, s[20:23], s34 offen lds
    s_add_u32 m0, s33, 100352
    s_add_u32 s34, s37, 16384
    buffer_load_dwordx4 v4, s[20:23], s34 offen lds
    s_add_u32 m0, s33, 101376
    s_add_u32 s34, s37, 24576
    buffer_load_dwordx4 v5, s[20:23], s34 offen lds
    s_add_u32 m0, s33, 114688
    s_add_u32 s34, s38, 0
    buffer_load_dwordx4 v6, s[24:27], s34 offen lds
    s_add_u32 m0, s33, 115712
    s_add_u32 s34, s38, 12288
    buffer_load_dwordx4 v6, s[24:27], s34 offen lds
    s_add_u32 m0, s33, 116736
    s_add_u32 s34, s38, 24576
    buffer_load_dwordx4 v6, s[24:27], s34 offen lds
    s_add_u32 m0, s33, 117760
    s_add_u32 s34, s38, 36864
    buffer_load_dwordx4 v6, s[24:27], s34 offen lds
    s_waitcnt vmcnt(8)
    s_barrier
    s_add_u32 s36, s35, 4
    s_and_b32 s36, s36, 7
    s_lshl_b32 s37, s36, 7
    s_add_u32 s37, s37, s31
    s_mul_i32 s38, s36, 196608
    s_add_u32 s38, s38, s32
    s_add_u32 m0, s33, 0
    s_add_u32 s34, s37, 0
    buffer_load_dwordx4 v4, s[20:23], s34 offen lds
    s_add_u32 m0, s33, 1024
    s_add_u32 s34, s37, 8192
    buffer_load_dwordx4 v5, s[20:23], s34 offen lds
    s_add_u32 m0, s33, 2048
    s_add_u32 s34, s37, 16384
    buffer_load_dwordx4 v4, s[20:23], s34 offen lds
    s_add_u32 m0, s33, 3072
    s_add_u32 s34, s37, 24576
    buffer_load_dwordx4 v5, s[20:23], s34 offen lds
    s_add_u32 m0, s33, 16384
    s_add_u32 s34, s38, 0
    buffer_load_dwordx4 v6, s[24:27], s34 offen lds
    s_add_u32 m0, s33, 17408
    s_add_u32 s34, s38, 12288
    buffer_load_dwordx4 v6, s[24:27], s34 offen lds
    s_add_u32 m0, s33, 18432
    s_add_u32 s34, s38, 24576
    buffer_load_dwordx4 v6, s[24:27], s34 offen lds
    s_add_u32 m0, s33, 19456
    s_add_u32 s34, s38, 36864
    buffer_load_dwordx4 v6, s[24:27], s34 offen lds
    s_waitcnt vmcnt(8)
    s_barrier
    s_add_u32 s36, s35, 5
    s_and_b32 s36, s36, 7
    s_lshl_b32 s37, s36, 7
    s_add_u32 s37, s37, s31
    s_mul_i32 s38, s36, 196608
    s_add_u32 s38, s38, s32
    s_add_u32 m0, s33, 32768
    s_add_u32 s34, s37, 0
    buffer_load_dwordx4 v4, s[20:23], s34 offen lds
    s_add_u32 m0, s33, 33792
    s_add_u32 s34, s37, 8192
    buffer_load_dwordx4 v5, s[20:23], s34 offen lds
    s_add_u32 m0, s33, 34816
    s_add_u32 s34, s37, 16384
    buffer_load_dwordx4 v4, s[20:23], s34 offen lds
    s_add_u32 m0, s33, 35840
    s_add_u32 s34, s37, 24576
    buffer_load_dwordx4 v5, s[20:23], s34 offen lds
    s_add_u32 m0, s33, 49152
    s_add_u32 s34, s38, 0
    buffer_load_dwordx4 v6, s[24:27], s34 offen lds
    s_add_u32 m0, s33, 50176
    s_add_u32 s34, s38, 12288
    buffer_load_dwordx4 v6, s[24:27], s34 offen lds
    s_add_u32 m0, s33, 51200
    s_add_u32 s34, s38, 24576
    buffer_load_dwordx4 v6, s[24:27], s34 offen lds
    s_add_u32 m0, s33, 52224
    s_add_u32 s34, s38, 36864
    buffer_load_dwordx4 v6, s[24:27], s34 offen lds
    s_waitcnt vmcnt(8)
    s_barrier
    s_add_u32 s36, s35, 6
    s_and_b32 s36, s36, 7
    s_lshl_b32 s37, s36, 7
    s_add_u32 s37, s37, s31
    s_mul_i32 s38, s36, 196608
    s_add_u32 s38, s38, s32
    s_add_u32 m0, s33, 65536
    s_add_u32 s34, s37, 0
    buffer_load_dwordx4 v4, s[20:23], s34 offen lds
    s_add_u32 m0, s33, 66560
    s_add_u32 s34, s37, 8192
    buffer_load_dwordx4 v5, s[20:23], s34 offen lds
    s_add_u32 m0, s33, 67584
    s_add_u32 s34, s37, 16384
    buffer_load_dwordx4 v4, s[20:23], s34 offen lds
    s_add_u32 m0, s33, 68608
    s_add_u32 s34, s37, 24576
    buffer_load_dwordx4 v5, s[20:23], s34 offen lds
    s_add_u32 m0, s33, 81920
    s_add_u32 s34, s38, 0
    buffer_load_dwordx4 v6, s[24:27], s34 offen lds
    s_add_u32 m0, s33, 82944
    s_add_u32 s34, s38, 12288
    buffer_load_dwordx4 v6, s[24:27], s34 offen lds
    s_add_u32 m0, s33, 83968
    s_add_u32 s34, s38, 24576
    buffer_load_dwordx4 v6, s[24:27], s34 offen lds
    s_add_u32 m0, s33, 84992
    s_add_u32 s34, s38, 36864
    buffer_load_dwordx4 v6, s[24:27], s34 offen lds
    s_waitcnt vmcnt(8)
    s_barrier
    s_add_u32 s36, s35, 7
    s_and_b32 s36, s36, 7
    s_lshl_b32 s37, s36, 7
    s_add_u32 s37, s37, s31
    s_mul_i32 s38, s36, 196608
    s_add_u32 s38, s38, s32
    s_add_u32 m0, s33, 98304
    s_add_u32 s34, s37, 0
    buffer_load_dwordx4 v4, s[20:23], s34 offen lds
    s_add_u32 m0, s33, 99328
    s_add_u32 s34, s37, 8192
    buffer_load_dwordx4 v5, s[20:23], s34 offen lds
    s_add_u32 m0, s33, 100352
    s_add_u32 s34, s37, 16384
    buffer_load_dwordx4 v4, s[20:23], s34 offen lds
    s_add_u32 m0, s33, 101376
    s_add_u32 s34, s37, 24576
    buffer_load_dwordx4 v5, s[20:23], s34 offen lds
    s_add_u32 m0, s33, 114688
    s_add_u32 s34, s38, 0
    buffer_load_dwordx4 v6, s[24:27], s34 offen lds
    s_add_u32 m0, s33, 115712
    s_add_u32 s34, s38, 12288
    buffer_load_dwordx4 v6, s[24:27], s34 offen lds
    s_add_u32 m0, s33, 116736
    s_add_u32 s34, s38, 24576
    buffer_load_dwordx4 v6, s[24:27], s34 offen lds
    s_add_u32 m0, s33, 117760
    s_add_u32 s34, s38, 36864
    buffer_load_dwordx4 v6, s[24:27], s34 offen lds
    s_waitcnt vmcnt(8)
    s_barrier
    s_waitcnt vmcnt(0)
    s_barrier
    s_endpgm
k1_compute:
    s_lshr_b32 s30, s3, 1
    s_and_b32 s31, s3, 1
    v_and_b32 v14, 31, v1
    v_lshrrev_b32 v15, 5, v1
    v_lshrrev_b32 v16, 1, v14
    v_and_b32 v16, 7, v16
    v_xor_b32 v16, v16, v15
    v_lshlrev_b32 v16, 4, v16
    v_lshl_add_u32 v16, v14, 7, v16
    s_lshl_b32 s32, s30, 13
    v_add_u32 v2, s32, v16
    v_xor_b32 v3, 32, v2
    v_xor_b32 v4, 64, v2
    v_xor_b32 v5, 96, v2
    v_add_u32 v6, 0x10000, v2
    v_add_u32 v7, 0x10000, v3
    v_add_u32 v8, 0x10000, v4
    v_add_u32 v9, 0x10000, v5
    v_and_b32 v16, 15, v1
    v_lshrrev_b32 v16, 2, v16
    v_lshl_add_u32 v17, v15, 3, v16
    v_lshlrev_b32 v17, 8, v17
    s_lshl_b32 s32, s31, 1
    v_xor_b32 v18, s32, v16
    v_lshl_add_u32 v17, v18, 6, v17
    v_lshrrev_b32 v18, 4, v1
    v_and_b32 v18, 1, v18
    v_lshl_add_u32 v17, v18, 5, v17
    v_and_b32 v18, 3, v1
    v_lshl_add_u32 v17, v18, 3, v17
    v_add_u32 v10, 16384, v17
    v_xor_b32 v11, 64, v10
    v_add_u32 v12, 0x10000, v10
    v_add_u32 v13, 0x10000, v11
    v_mov_b32 v64, 0
    v_mov_b32 v65, 0
    v_mov_b32 v66, 0
    v_mov_b32 v67, 0
    v_mov_b32 v68, 0
    v_mov_b32 v69, 0
    v_mov_b32 v70, 0
    v_mov_b32 v71, 0
    v_mov_b32 v72, 0
    v_mov_b32 v73, 0
    v_mov_b32 v74, 0
    v_mov_b32 v75, 0
    v_mov_b32 v76, 0
    v_mov_b32 v77, 0
    v_mov_b32 v78, 0
    v_mov_b32 v79, 0
    v_mov_b32 v80, 0
    v_mov_b32 v81, 0
    v_mov_b32 v82, 0
    v_mov_b32 v83, 0
    v_mov_b32 v84, 0
    v_mov_b32 v85, 0
    v_mov_b32 v86, 0
    v_mov_b32 v87, 0
    v_mov_b32 v88, 0
    v_mov_b32 v89, 0
    v_mov_b32 v90, 0
    v_mov_b32 v91, 0
    v_mov_b32 v92, 0
    v_mov_b32 v93, 0
    v_mov_b32 v94, 0
    v_mov_b32 v95, 0
    v_mov_b32 v96, 0
    v_mov_b32 v97, 0
    v_mov_b32 v98, 0
    v_mov_b32 v99, 0
    v_mov_b32 v100, 0
    v_mov_b32 v101, 0
    v_mov_b32 v102, 0
    v_mov_b32 v103, 0
    v_mov_b32 v104, 0
    v_mov_b32 v105, 0
    v_mov_b32 v106, 0
    v_mov_b32 v107, 0
    v_mov_b32 v108, 0
    v_mov_b32 v109, 0
    v_mov_b32 v110, 0
    v_mov_b32 v111, 0
    v_mov_b32 v112, 0
    v_mov_b32 v113, 0
    v_mov_b32 v114, 0
    v_mov_b32 v115, 0
    v_mov_b32 v116, 0
    v_mov_b32 v117, 0
    v_mov_b32 v118, 0
    v_mov_b32 v119, 0
    v_mov_b32 v120, 0
    v_mov_b32 v121, 0
    v_mov_b32 v122, 0
    v_mov_b32 v123, 0
    v_mov_b32 v124, 0
    v_mov_b32 v125, 0
    v_mov_b32 v126, 0
    v_mov_b32 v127, 0
    s_waitcnt lgkmcnt(0)
    s_mov_b32 s20, s16
    s_and_b32 s21, s17, 0xffff
    s_mov_b32 s22, 268435456
    s_mov_b32 s23, 0x20000
    s_cmp_ge_u32 s29, 8
    s_cbranch_scc1 k1_vloop
    s_barrier
    ds_read_b128 v[16:19], v2 offset:0
    ds_read_b64_tr_b16 v[24:25], v10 offset:0
    ds_read_b64_tr_b16 v[26:27], v10 offset:1024
    ds_read_b128 v[20:23], v2 offset:4096
    ds_read_b64_tr_b16 v[28:29], v11 offset:0
    ds_read_b64_tr_b16 v[30:31], v11 offset:1024
    ds_read_b128 v[32:35], v3 offset:0
    ds_read_b64_tr_b16 v[40:41], v10 offset:4096
    ds_read_b64_tr_b16 v[42:43], v10 offset:5120
    ds_read_b128 v[36:39], v3 offset:4096
    ds_read_b64_tr_b16 v[44:45], v11 offset:4096
    ds_read_b64_tr_b16 v[46:47], v11 offset:5120
    s_waitcnt lgkmcnt(6)
    v_mfma_f32_32x32x16_bf16 v[64:79], v[24:27], v[16:19], v[64:79]
    v_mfma_f32_32x32x16_bf16 v[80:95], v[24:27], v[20:23], v[80:95]
    v_mfma_f32_32x32x16_bf16 v[96:111], v[28:31], v[16:19], v[96:111]
    v_mfma_f32_32x32x16_bf16 v[112:127], v[28:31], v[20:23], v[112:127]
    ds_read_b128 v[16:19], v4 offset:0
    ds_read_b64_tr_b16 v[24:25], v10 offset:8192
    ds_read_b64_tr_b16 v[26:27], v10 offset:9216
    ds_read_b128 v[20:23], v4 offset:4096
    ds_read_b64_tr_b16 v[28:29], v11 offset:8192
    ds_read_b64_tr_b16 v[30:31], v11 offset:9216
    s_waitcnt lgkmcnt(6)
    v_mfma_f32_32x32x16_bf16 v[64:79], v[40:43], v[32:35], v[64:79]
    v_mfma_f32_32x32x16_bf16 v[80:95], v[40:43], v[36:39], v[80:95]
    v_mfma_f32_32x32x16_bf16 v[96:111], v[44:47], v[32:35], v[96:111]
    v_mfma_f32_32x32x16_bf16 v[112:127], v[44:47], v[36:39], v[112:127]
    ds_read_b128 v[32:35], v5 offset:0
    ds_read_b64_tr_b16 v[40:41], v10 offset:12288
    ds_read_b64_tr_b16 v[42:43], v10 offset:13312
    ds_read_b128 v[36:39], v5 offset:4096
    ds_read_b64_tr_b16 v[44:45], v11 offset:12288
    ds_read_b64_tr_b16 v[46:47], v11 offset:13312
    s_waitcnt lgkmcnt(6)
    v_mfma_f32_32x32x16_bf16 v[64:79], v[24:27], v[16:19], v[64:79]
    v_mfma_f32_32x32x16_bf16 v[80:95], v[24:27], v[20:23], v[80:95]
    v_mfma_f32_32x32x16_bf16 v[96:111], v[28:31], v[16:19], v[96:111]
    v_mfma_f32_32x32x16_bf16 v[112:127], v[28:31], v[20:23], v[112:127]
    s_waitcnt lgkmcnt(0)
    s_barrier
    ds_read_b128 v[16:19], v2 offset:32768
    ds_read_b64_tr_b16 v[24:25], v10 offset:32768
    ds_read_b64_tr_b16 v[26:27], v10 offset:33792
    ds_read_b128 v[20:23], v2 offset:36864
    ds_read_b64_tr_b16 v[28:29], v11 offset:32768
    ds_read_b64_tr_b16 v[30:31], v11 offset:33792
    v_mfma_f32_32x32x16_bf16 v[64:79], v[40:43], v[32:35], v[64:79]
    v_mfma_f32_32x32x16_bf16 v[80:95], v[40:43], v[36:39], v[80:95]
    v_mfma_f32_32x32x16_bf16 v[96:111], v[44:47], v[32:35], v[96:111]
    v_mfma_f32_32x32x16_bf16 v[112:127], v[44:47], v[36:39], v[112:127]
    ds_read_b128 v[32:35], v3 offset:32768
    ds_read_b64_tr_b16 v[40:41], v10 offset:36864
    ds_read_b64_tr_b16 v[42:43], v10 offset:37888
    ds_read_b128 v[36:39], v3 offset:36864
    ds_read_b64_tr_b16 v[44:45], v11 offset:36864
    ds_read_b64_tr_b16 v[46:47], v11 offset:37888
    s_waitcnt lgkmcnt(6)
    v_mfma_f32_32x32x16_bf16 v[64:79], v[24:27], v[16:19], v[64:79]
    v_mfma_f32_32x32x16_bf16 v[80:95], v[24:27], v[20:23], v[80:95]
    v_mfma_f32_32x32x16_bf16 v[96:111], v[28:31], v[16:19], v[96:111]
    v_mfma_f32_32x32x16_bf16 v[112:127], v[28:31], v[20:23], v[112:127]
    ds_read_b128 v[16:19], v4 offset:32768
    ds_read_b64_tr_b16 v[24:25], v10 offset:40960
    ds_read_b64_tr_b16 v[26:27], v10 offset:41984
    ds_read_b128 v[20:23], v4 offset:36864
    ds_read_b64_tr_b16 v[28:29], v11 offset:40960
    ds_read_b64_tr_b16 v[30:31], v11 offset:41984
    s_waitcnt lgkmcnt(6)
    v_mfma_f32_32x32x16_bf16 v[64:79], v[40:43], v[32:35], v[64:79]
    v_mfma_f32_32x32x16_bf16 v[80:95], v[40:43], v[36:39], v[80:95]
    v_mfma_f32_32x32x16_bf16 v[96:111], v[44:47], v[32:35], v[96:111]
    v_mfma_f32_32x32x16_bf16 v[112:127], v[44:47], v[36:39], v[112:127]
    ds_read_b128 v[32:35], v5 offset:32768
    ds_read_b64_tr_b16 v[40:41], v10 offset:45056
    ds_read_b64_tr_b16 v[42:43], v10 offset:46080
    ds_read_b128 v[36:39], v5 offset:36864
    ds_read_b64_tr_b16 v[44:45], v11 offset:45056
    ds_read_b64_tr_b16 v[46:47], v11 offset:46080
    s_waitcnt lgkmcnt(6)
    v_mfma_f32_32x32x16_bf16 v[64:79], v[24:27], v[16:19], v[64:79]
    v_mfma_f32_32x32x16_bf16 v[80:95], v[24:27], v[20:23], v[80:95]
    v_mfma_f32_32x32x16_bf16 v[96:111], v[28:31], v[16:19], v[96:111]
    v_mfma_f32_32x32x16_bf16 v[112:127], v[28:31], v[20:23], v[112:127]
    s_waitcnt lgkmcnt(0)
    s_barrier
    ds_read_b128 v[16:19], v6 offset:0
    ds_read_b64_tr_b16 v[24:25], v12 offset:0
    ds_read_b64_tr_b16 v[26:27], v12 offset:1024
    ds_read_b128 v[20:23], v6 offset:4096
    ds_read_b64_tr_b16 v[28:29], v13 offset:0
    ds_read_b64_tr_b16 v[30:31], v13 offset:1024
    v_mfma_f32_32x32x16_bf16 v[64:79], v[40:43], v[32:35], v[64:79]
    v_mfma_f32_32x32x16_bf16 v[80:95], v[40:43], v[36:39], v[80:95]
    v_mfma_f32_32x32x16_bf16 v[96:111], v[44:47], v[32:35], v[96:111]
    v_mfma_f32_32x32x16_bf16 v[112:127], v[44:47], v[36:39], v[112:127]
    ds_read_b128 v[32:35], v7 offset:0
    ds_read_b64_tr_b16 v[40:41], v12 offset:4096
    ds_read_b64_tr_b16 v[42:43], v12 offset:5120
    ds_read_b128 v[36:39], v7 offset:4096
    ds_read_b64_tr_b16 v[44:45], v13 offset:4096
    ds_read_b64_tr_b16 v[46:47], v13 offset:5120
    s_waitcnt lgkmcnt(6)
    v_mfma_f32_32x32x16_bf16 v[64:79], v[24:27], v[16:19], v[64:79]
    v_mfma_f32_32x32x16_bf16 v[80:95], v[24:27], v[20:23], v[80:95]
    v_mfma_f32_32x32x16_bf16 v[96:111], v[28:31], v[16:19], v[96:111]
    v_mfma_f32_32x32x16_bf16 v[112:127], v[28:31], v[20:23], v[112:127]
    ds_read_b128 v[16:19], v8 offset:0
    ds_read_b64_tr_b16 v[24:25], v12 offset:8192
    ds_read_b64_tr_b16 v[26:27], v12 offset:9216
    ds_read_b128 v[20:23], v8 offset:4096
    ds_read_b64_tr_b16 v[28:29], v13 offset:8192
    ds_read_b64_tr_b16 v[30:31], v13 offset:9216
    s_waitcnt lgkmcnt(6)
    v_mfma_f32_32x32x16_bf16 v[64:79], v[40:43], v[32:35], v[64:79]
    v_mfma_f32_32x32x16_bf16 v[80:95], v[40:43], v[36:39], v[80:95]
    v_mfma_f32_32x32x16_bf16 v[96:111], v[44:47], v[32:35], v[96:111]
    v_mfma_f32_32x32x16_bf16 v[112:127], v[44:47], v[36:39], v[112:127]
    ds_read_b128 v[32:35], v9 offset:0
    ds_read_b64_tr_b16 v[40:41], v12 offset:12288
    ds_read_b64_tr_b16 v[42:43], v12 offset:13312
    ds_read_b128 v[36:39], v9 offset:4096
    ds_read_b64_tr_b16 v[44:45], v13 offset:12288
    ds_read_b64_tr_b16 v[46:47], v13 offset:13312
    s_waitcnt lgkmcnt(6)
    v_mfma_f32_32x32x16_bf16 v[64:79], v[24:27], v[16:19], v[64:79]
    v_mfma_f32_32x32x16_bf16 v[80:95], v[24:27], v[20:23], v[80:95]
    v_mfma_f32_32x32x16_bf16 v[96:111], v[28:31], v[16:19], v[96:111]
    v_mfma_f32_32x32x16_bf16 v[112:127], v[28:31], v[20:23], v[112:127]
    s_waitcnt lgkmcnt(0)
    s_barrier
    ds_read_b128 v[16:19], v6 offset:32768
    ds_read_b64_tr_b16 v[24:25], v12 offset:32768
    ds_read_b64_tr_b16 v[26:27], v12 offset:33792
    ds_read_b128 v[20:23], v6 offset:36864
    ds_read_b64_tr_b16 v[28:29], v13 offset:32768
    ds_read_b64_tr_b16 v[30:31], v13 offset:33792
    v_mfma_f32_32x32x16_bf16 v[64:79], v[40:43], v[32:35], v[64:79]
    v_mfma_f32_32x32x16_bf16 v[80:95], v[40:43], v[36:39], v[80:95]
    v_mfma_f32_32x32x16_bf16 v[96:111], v[44:47], v[32:35], v[96:111]
    v_mfma_f32_32x32x16_bf16 v[112:127], v[44:47], v[36:39], v[112:127]
    ds_read_b128 v[32:35], v7 offset:32768
    ds_read_b64_tr_b16 v[40:41], v12 offset:36864
    ds_read_b64_tr_b16 v[42:43], v12 offset:37888
    ds_read_b128 v[36:39], v7 offset:36864
    ds_read_b64_tr_b16 v[44:45], v13 offset:36864
    ds_read_b64_tr_b16 v[46:47], v13 offset:37888
    s_waitcnt lgkmcnt(6)
    v_mfma_f32_32x32x16_bf16 v[64:79], v[24:27], v[16:19], v[64:79]
    v_mfma_f32_32x32x16_bf16 v[80:95], v[24:27], v[20:23], v[80:95]
    v_mfma_f32_32x32x16_bf16 v[96:111], v[28:31], v[16:19], v[96:111]
    v_mfma_f32_32x32x16_bf16 v[112:127], v[28:31], v[20:23], v[112:127]
    ds_read_b128 v[16:19], v8 offset:32768
    ds_read_b64_tr_b16 v[24:25], v12 offset:40960
    ds_read_b64_tr_b16 v[26:27], v12 offset:41984
    ds_read_b128 v[20:23], v8 offset:36864
    ds_read_b64_tr_b16 v[28:29], v13 offset:40960
    ds_read_b64_tr_b16 v[30:31], v13 offset:41984
    s_waitcnt lgkmcnt(6)
    v_mfma_f32_32x32x16_bf16 v[64:79], v[40:43], v[32:35], v[64:79]
    v_mfma_f32_32x32x16_bf16 v[80:95], v[40:43], v[36:39], v[80:95]
    v_mfma_f32_32x32x16_bf16 v[96:111], v[44:47], v[32:35], v[96:111]
    v_mfma_f32_32x32x16_bf16 v[112:127], v[44:47], v[36:39], v[112:127]
    ds_read_b128 v[32:35], v9 offset:32768
    ds_read_b64_tr_b16 v[40:41], v12 offset:45056
    ds_read_b64_tr_b16 v[42:43], v12 offset:46080
    ds_read_b128 v[36:39], v9 offset:36864
    ds_read_b64_tr_b16 v[44:45], v13 offset:45056
    ds_read_b64_tr_b16 v[46:47], v13 offset:46080
    s_waitcnt lgkmcnt(6)
    v_mfma_f32_32x32x16_bf16 v[64:79], v[24:27], v[16:19], v[64:79]
    v_mfma_f32_32x32x16_bf16 v[80:95], v[24:27], v[20:23], v[80:95]
    v_mfma_f32_32x32x16_bf16 v[96:111], v[28:31], v[16:19], v[96:111]
    v_mfma_f32_32x32x16_bf16 v[112:127], v[28:31], v[20:23], v[112:127]
    s_waitcnt lgkmcnt(0)
    s_barrier
    ds_read_b128 v[16:19], v2 offset:0
    ds_read_b64_tr_b16 v[24:25], v10 offset:0
    ds_read_b64_tr_b16 v[26:27], v10 offset:1024
    ds_read_b128 v[20:23], v2 offset:4096
    ds_read_b64_tr_b16 v[28:29], v11 offset:0
    ds_read_b64_tr_b16 v[30:31], v11 offset:1024
    v_mfma_f32_32x32x16_bf16 v[64:79], v[40:43], v[32:35], v[64:79]
    v_mfma_f32_32x32x16_bf16 v[80:95], v[40:43], v[36:39], v[80:95]
    v_mfma_f32_32x32x16_bf16 v[96:111], v[44:47], v[32:35], v[96:111]
    v_mfma_f32_32x32x16_bf16 v[112:127], v[44:47], v[36:39], v[112:127]
    ds_read_b128 v[32:35], v3 offset:0
    ds_read_b64_tr_b16 v[40:41], v10 offset:4096
    ds_read_b64_tr_b16 v[42:43], v10 offset:5120
    ds_read_b128 v[36:39], v3 offset:4096
    ds_read_b64_tr_b16 v[44:45], v11 offset:4096
    ds_read_b64_tr_b16 v[46:47], v11 offset:5120
    s_waitcnt lgkmcnt(6)
    v_mfma_f32_32x32x16_bf16 v[64:79], v[24:27], v[16:19], v[64:79]
    v_mfma_f32_32x32x16_bf16 v[80:95], v[24:27], v[20:23], v[80:95]
    v_mfma_f32_32x32x16_bf16 v[96:111], v[28:31], v[16:19], v[96:111]
    v_mfma_f32_32x32x16_bf16 v[112:127], v[28:31], v[20:23], v[112:127]
    ds_read_b128 v[16:19], v4 offset:0
    ds_read_b64_tr_b16 v[24:25], v10 offset:8192
    ds_read_b64_tr_b16 v[26:27], v10 offset:9216
    ds_read_b128 v[20:23], v4 offset:4096
    ds_read_b64_tr_b16 v[28:29], v11 offset:8192
    ds_read_b64_tr_b16 v[30:31], v11 offset:9216
    s_waitcnt lgkmcnt(6)
    v_mfma_f32_32x32x16_bf16 v[64:79], v[40:43], v[32:35], v[64:79]
    v_mfma_f32_32x32x16_bf16 v[80:95], v[40:43], v[36:39], v[80:95]
    v_mfma_f32_32x32x16_bf16 v[96:111], v[44:47], v[32:35], v[96:111]
    v_mfma_f32_32x32x16_bf16 v[112:127], v[44:47], v[36:39], v[112:127]
    ds_read_b128 v[32:35], v5 offset:0
    ds_read_b64_tr_b16 v[40:41], v10 offset:12288
    ds_read_b64_tr_b16 v[42:43], v10 offset:13312
    ds_read_b128 v[36:39], v5 offset:4096
    ds_read_b64_tr_b16 v[44:45], v11 offset:12288
    ds_read_b64_tr_b16 v[46:47], v11 offset:13312
    s_waitcnt lgkmcnt(6)
    v_mfma_f32_32x32x16_bf16 v[64:79], v[24:27], v[16:19], v[64:79]
    v_mfma_f32_32x32x16_bf16 v[80:95], v[24:27], v[20:23], v[80:95]
    v_mfma_f32_32x32x16_bf16 v[96:111], v[28:31], v[16:19], v[96:111]
    v_mfma_f32_32x32x16_bf16 v[112:127], v[28:31], v[20:23], v[112:127]
    s_waitcnt lgkmcnt(0)
    s_barrier
    ds_read_b128 v[16:19], v2 offset:32768
    ds_read_b64_tr_b16 v[24:25], v10 offset:32768
    ds_read_b64_tr_b16 v[26:27], v10 offset:33792
    ds_read_b128 v[20:23], v2 offset:36864
    ds_read_b64_tr_b16 v[28:29], v11 offset:32768
    ds_read_b64_tr_b16 v[30:31], v11 offset:33792
    v_mfma_f32_32x32x16_bf16 v[64:79], v[40:43], v[32:35], v[64:79]
    v_mfma_f32_32x32x16_bf16 v[80:95], v[40:43], v[36:39], v[80:95]
    v_mfma_f32_32x32x16_bf16 v[96:111], v[44:47], v[32:35], v[96:111]
    v_mfma_f32_32x32x16_bf16 v[112:127], v[44:47], v[36:39], v[112:127]
    ds_read_b128 v[32:35], v3 offset:32768
    ds_read_b64_tr_b16 v[40:41], v10 offset:36864
    ds_read_b64_tr_b16 v[42:43], v10 offset:37888
    ds_read_b128 v[36:39], v3 offset:36864
    ds_read_b64_tr_b16 v[44:45], v11 offset:36864
    ds_read_b64_tr_b16 v[46:47], v11 offset:37888
    s_waitcnt lgkmcnt(6)
    v_mfma_f32_32x32x16_bf16 v[64:79], v[24:27], v[16:19], v[64:79]
    v_mfma_f32_32x32x16_bf16 v[80:95], v[24:27], v[20:23], v[80:95]
    v_mfma_f32_32x32x16_bf16 v[96:111], v[28:31], v[16:19], v[96:111]
    v_mfma_f32_32x32x16_bf16 v[112:127], v[28:31], v[20:23], v[112:127]
    ds_read_b128 v[16:19], v4 offset:32768
    ds_read_b64_tr_b16 v[24:25], v10 offset:40960
    ds_read_b64_tr_b16 v[26:27], v10 offset:41984
    ds_read_b128 v[20:23], v4 offset:36864
    ds_read_b64_tr_b16 v[28:29], v11 offset:40960
    ds_read_b64_tr_b16 v[30:31], v11 offset:41984
    s_waitcnt lgkmcnt(6)
    v_mfma_f32_32x32x16_bf16 v[64:79], v[40:43], v[32:35], v[64:79]
    v_mfma_f32_32x32x16_bf16 v[80:95], v[40:43], v[36:39], v[80:95]
    v_mfma_f32_32x32x16_bf16 v[96:111], v[44:47], v[32:35], v[96:111]
    v_mfma_f32_32x32x16_bf16 v[112:127], v[44:47], v[36:39], v[112:127]
    ds_read_b128 v[32:35], v5 offset:32768
    ds_read_b64_tr_b16 v[40:41], v10 offset:45056
    ds_read_b64_tr_b16 v[42:43], v10 offset:46080
    ds_read_b128 v[36:39], v5 offset:36864
    ds_read_b64_tr_b16 v[44:45], v11 offset:45056
    ds_read_b64_tr_b16 v[46:47], v11 offset:46080
    s_waitcnt lgkmcnt(6)
    v_mfma_f32_32x32x16_bf16 v[64:79], v[24:27], v[16:19], v[64:79]
    v_mfma_f32_32x32x16_bf16 v[80:95], v[24:27], v[20:23], v[80:95]
    v_mfma_f32_32x32x16_bf16 v[96:111], v[28:31], v[16:19], v[96:111]
    v_mfma_f32_32x32x16_bf16 v[112:127], v[28:31], v[20:23], v[112:127]
    s_waitcnt lgkmcnt(0)
    s_barrier
    ds_read_b128 v[16:19], v6 offset:0
    ds_read_b64_tr_b16 v[24:25], v12 offset:0
    ds_read_b64_tr_b16 v[26:27], v12 offset:1024
    ds_read_b128 v[20:23], v6 offset:4096
    ds_read_b64_tr_b16 v[28:29], v13 offset:0
    ds_read_b64_tr_b16 v[30:31], v13 offset:1024
    v_mfma_f32_32x32x16_bf16 v[64:79], v[40:43], v[32:35], v[64:79]
    v_mfma_f32_32x32x16_bf16 v[80:95], v[40:43], v[36:39], v[80:95]
    v_mfma_f32_32x32x16_bf16 v[96:111], v[44:47], v[32:35], v[96:111]
    v_mfma_f32_32x32x16_bf16 v[112:127], v[44:47], v[36:39], v[112:127]
    ds_read_b128 v[32:35], v7 offset:0
    ds_read_b64_tr_b16 v[40:41], v12 offset:4096
    ds_read_b64_tr_b16 v[42:43], v12 offset:5120
    ds_read_b128 v[36:39], v7 offset:4096
    ds_read_b64_tr_b16 v[44:45], v13 offset:4096
    ds_read_b64_tr_b16 v[46:47], v13 offset:5120
    s_waitcnt lgkmcnt(6)
    v_mfma_f32_32x32x16_bf16 v[64:79], v[24:27], v[16:19], v[64:79]
    v_mfma_f32_32x32x16_bf16 v[80:95], v[24:27], v[20:23], v[80:95]
    v_mfma_f32_32x32x16_bf16 v[96:111], v[28:31], v[16:19], v[96:111]
    v_mfma_f32_32x32x16_bf16 v[112:127], v[28:31], v[20:23], v[112:127]
    ds_read_b128 v[16:19], v8 offset:0
    ds_read_b64_tr_b16 v[24:25], v12 offset:8192
    ds_read_b64_tr_b16 v[26:27], v12 offset:9216
    ds_read_b128 v[20:23], v8 offset:4096
    ds_read_b64_tr_b16 v[28:29], v13 offset:8192
    ds_read_b64_tr_b16 v[30:31], v13 offset:9216
    s_waitcnt lgkmcnt(6)
    v_mfma_f32_32x32x16_bf16 v[64:79], v[40:43], v[32:35], v[64:79]
    v_mfma_f32_32x32x16_bf16 v[80:95], v[40:43], v[36:39], v[80:95]
    v_mfma_f32_32x32x16_bf16 v[96:111], v[44:47], v[32:35], v[96:111]
    v_mfma_f32_32x32x16_bf16 v[112:127], v[44:47], v[36:39], v[112:127]
    ds_read_b128 v[32:35], v9 offset:0
    ds_read_b64_tr_b16 v[40:41], v12 offset:12288
    ds_read_b64_tr_b16 v[42:43], v12 offset:13312
    ds_read_b128 v[36:39], v9 offset:4096
    ds_read_b64_tr_b16 v[44:45], v13 offset:12288
    ds_read_b64_tr_b16 v[46:47], v13 offset:13312
    s_waitcnt lgkmcnt(6)
    v_mfma_f32_32x32x16_bf16 v[64:79], v[24:27], v[16:19], v[64:79]
    v_mfma_f32_32x32x16_bf16 v[80:95], v[24:27], v[20:23], v[80:95]
    v_mfma_f32_32x32x16_bf16 v[96:111], v[28:31], v[16:19], v[96:111]
    v_mfma_f32_32x32x16_bf16 v[112:127], v[28:31], v[20:23], v[112:127]
    s_waitcnt lgkmcnt(0)
    s_barrier
    ds_read_b128 v[16:19], v6 offset:32768
    ds_read_b64_tr_b16 v[24:25], v12 offset:32768
    ds_read_b64_tr_b16 v[26:27], v12 offset:33792
    ds_read_b128 v[20:23], v6 offset:36864
    ds_read_b64_tr_b16 v[28:29], v13 offset:32768
    ds_read_b64_tr_b16 v[30:31], v13 offset:33792
    v_mfma_f32_32x32x16_bf16 v[64:79], v[40:43], v[32:35], v[64:79]
    v_mfma_f32_32x32x16_bf16 v[80:95], v[40:43], v[36:39], v[80:95]
    v_mfma_f32_32x32x16_bf16 v[96:111], v[44:47], v[32:35], v[96:111]
    v_mfma_f32_32x32x16_bf16 v[112:127], v[44:47], v[36:39], v[112:127]
    ds_read_b128 v[32:35], v7 offset:32768
    ds_read_b64_tr_b16 v[40:41], v12 offset:36864
    ds_read_b64_tr_b16 v[42:43], v12 offset:37888
    ds_read_b128 v[36:39], v7 offset:36864
    ds_read_b64_tr_b16 v[44:45], v13 offset:36864
    ds_read_b64_tr_b16 v[46:47], v13 offset:37888
    s_waitcnt lgkmcnt(6)
    v_mfma_f32_32x32x16_bf16 v[64:79], v[24:27], v[16:19], v[64:79]
    v_mfma_f32_32x32x16_bf16 v[80:95], v[24:27], v[20:23], v[80:95]
    v_mfma_f32_32x32x16_bf16 v[96:111], v[28:31], v[16:19], v[96:111]
    v_mfma_f32_32x32x16_bf16 v[112:127], v[28:31], v[20:23], v[112:127]
    ds_read_b128 v[16:19], v8 offset:32768
    ds_read_b64_tr_b16 v[24:25], v12 offset:40960
    ds_read_b64_tr_b16 v[26:27], v12 offset:41984
    ds_read_b128 v[20:23], v8 offset:36864
    ds_read_b64_tr_b16 v[28:29], v13 offset:40960
    ds_read_b64_tr_b16 v[30:31], v13 offset:41984
    s_waitcnt lgkmcnt(6)
    v_mfma_f32_32x32x16_bf16 v[64:79], v[40:43], v[32:35], v[64:79]
    v_mfma_f32_32x32x16_bf16 v[80:95], v[40:43], v[36:39], v[80:95]
    v_mfma_f32_32x32x16_bf16 v[96:111], v[44:47], v[32:35], v[96:111]
    v_mfma_f32_32x32x16_bf16 v[112:127], v[44:47], v[36:39], v[112:127]
    ds_read_b128 v[32:35], v9 offset:32768
    ds_read_b64_tr_b16 v[40:41], v12 offset:45056
    ds_read_b64_tr_b16 v[42:43], v12 offset:46080
    ds_read_b128 v[36:39], v9 offset:36864
    ds_read_b64_tr_b16 v[44:45], v13 offset:45056
    ds_read_b64_tr_b16 v[46:47], v13 offset:46080
    s_waitcnt lgkmcnt(6)
    v_mfma_f32_32x32x16_bf16 v[64:79], v[24:27], v[16:19], v[64:79]
    v_mfma_f32_32x32x16_bf16 v[80:95], v[24:27], v[20:23], v[80:95]
    v_mfma_f32_32x32x16_bf16 v[96:111], v[28:31], v[16:19], v[96:111]
    v_mfma_f32_32x32x16_bf16 v[112:127], v[28:31], v[20:23], v[112:127]
    s_waitcnt lgkmcnt(0)
    v_mfma_f32_32x32x16_bf16 v[64:79], v[40:43], v[32:35], v[64:79]
    v_mfma_f32_32x32x16_bf16 v[80:95], v[40:43], v[36:39], v[80:95]
    v_mfma_f32_32x32x16_bf16 v[96:111], v[44:47], v[32:35], v[96:111]
    v_mfma_f32_32x32x16_bf16 v[112:127], v[44:47], v[36:39], v[112:127]
    s_and_b32 s33, s29, 3
    s_lshl_b32 s33, s33, 3
    s_lshl_b32 s34, s31, 2
    s_add_u32 s33, s33, s34
    s_lshl_b32 s34, s28, 2
    s_lshl_b32 s35, s30, 1
    s_add_u32 s34, s34, s35
    s_cmp_ge_u32 s29, 4
    s_cbranch_scc1 k1_kepi
    v_lshlrev_b32 v2, 9, v15
    v_lshl_add_u32 v2, v14, 4, v2
    s_lshl_b32 s35, s33, 16
    s_lshl_b32 s36, s34, 10
    s_add_u32 s35, s35, s36
    s_add_u32 s35, s35, 0
    s_mov_b32 s38, 0x3eb8aa3b
    s_mov_b32 s39, 0x3eb8aa3b
    s_nop 7
    v_pk_mul_f32 v[64:65], v[64:65], s[38:39]
    v_pk_mul_f32 v[66:67], v[66:67], s[38:39]
    v_pk_mul_f32 v[68:69], v[68:69], s[38:39]
    v_pk_mul_f32 v[70:71], v[70:71], s[38:39]
    v_pk_mul_f32 v[72:73], v[72:73], s[38:39]
    v_pk_mul_f32 v[74:75], v[74:75], s[38:39]
    v_pk_mul_f32 v[76:77], v[76:77], s[38:39]
    v_pk_mul_f32 v[78:79], v[78:79], s[38:39]
    v_cvt_pk_bf16_f32 v16, v64, v65
    v_cvt_pk_bf16_f32 v17, v66, v67
    v_cvt_pk_bf16_f32 v18, v68, v69
    v_cvt_pk_bf16_f32 v19, v70, v71
    v_cvt_pk_bf16_f32 v20, v72, v73
    v_cvt_pk_bf16_f32 v21, v74, v75
    v_cvt_pk_bf16_f32 v22, v76, v77
    v_cvt_pk_bf16_f32 v23, v78, v79
    s_add_u32 s36, s35, 0
    buffer_store_dwordx4 v[16:19], v2, s[20:23], s36 offen sc1
    s_add_u32 s36, s35, 65536
    buffer_store_dwordx4 v[20:23], v2, s[20:23], s36 offen sc1
    v_pk_mul_f32 v[80:81], v[80:81], s[38:39]
    v_pk_mul_f32 v[82:83], v[82:83], s[38:39]
    v_pk_mul_f32 v[84:85], v[84:85], s[38:39]
    v_pk_mul_f32 v[86:87], v[86:87], s[38:39]
    v_pk_mul_f32 v[88:89], v[88:89], s[38:39]
    v_pk_mul_f32 v[90:91], v[90:91], s[38:39]
    v_pk_mul_f32 v[92:93], v[92:93], s[38:39]
    v_pk_mul_f32 v[94:95], v[94:95], s[38:39]
    v_cvt_pk_bf16_f32 v24, v80, v81
    v_cvt_pk_bf16_f32 v25, v82, v83
    v_cvt_pk_bf16_f32 v26, v84, v85
    v_cvt_pk_bf16_f32 v27, v86, v87
    v_cvt_pk_bf16_f32 v28, v88, v89
    v_cvt_pk_bf16_f32 v29, v90, v91
    v_cvt_pk_bf16_f32 v30, v92, v93
    v_cvt_pk_bf16_f32 v31, v94, v95
    s_add_u32 s36, s35, 1024
    buffer_store_dwordx4 v[24:27], v2, s[20:23], s36 offen sc1
    s_add_u32 s36, s35, 66560
    buffer_store_dwordx4 v[28:31], v2, s[20:23], s36 offen sc1
    v_pk_mul_f32 v[96:97], v[96:97], s[38:39]
    v_pk_mul_f32 v[98:99], v[98:99], s[38:39]
    v_pk_mul_f32 v[100:101], v[100:101], s[38:39]
    v_pk_mul_f32 v[102:103], v[102:103], s[38:39]
    v_pk_mul_f32 v[104:105], v[104:105], s[38:39]
    v_pk_mul_f32 v[106:107], v[106:107], s[38:39]
    v_pk_mul_f32 v[108:109], v[108:109], s[38:39]
    v_pk_mul_f32 v[110:111], v[110:111], s[38:39]
    v_cvt_pk_bf16_f32 v32, v96, v97
    v_cvt_pk_bf16_f32 v33, v98, v99
    v_cvt_pk_bf16_f32 v34, v100, v101
    v_cvt_pk_bf16_f32 v35, v102, v103
    v_cvt_pk_bf16_f32 v36, v104, v105
    v_cvt_pk_bf16_f32 v37, v106, v107
    v_cvt_pk_bf16_f32 v38, v108, v109
    v_cvt_pk_bf16_f32 v39, v110, v111
    s_add_u32 s36, s35, 131072
    buffer_store_dwordx4 v[32:35], v2, s[20:23], s36 offen sc1
    s_add_u32 s36, s35, 196608
    buffer_store_dwordx4 v[36:39], v2, s[20:23], s36 offen sc1
    v_pk_mul_f32 v[112:113], v[112:113], s[38:39]
    v_pk_mul_f32 v[114:115], v[114:115], s[38:39]
    v_pk_mul_f32 v[116:117], v[116:117], s[38:39]
    v_pk_mul_f32 v[118:119], v[118:119], s[38:39]
    v_pk_mul_f32 v[120:121], v[120:121], s[38:39]
    v_pk_mul_f32 v[122:123], v[122:123], s[38:39]
    v_pk_mul_f32 v[124:125], v[124:125], s[38:39]
    v_pk_mul_f32 v[126:127], v[126:127], s[38:39]
    v_cvt_pk_bf16_f32 v40, v112, v113
    v_cvt_pk_bf16_f32 v41, v114, v115
    v_cvt_pk_bf16_f32 v42, v116, v117
    v_cvt_pk_bf16_f32 v43, v118, v119
    v_cvt_pk_bf16_f32 v44, v120, v121
    v_cvt_pk_bf16_f32 v45, v122, v123
    v_cvt_pk_bf16_f32 v46, v124, v125
    v_cvt_pk_bf16_f32 v47, v126, v127
    s_add_u32 s36, s35, 132096
    buffer_store_dwordx4 v[40:43], v2, s[20:23], s36 offen sc1
    s_add_u32 s36, s35, 197632
    buffer_store_dwordx4 v[44:47], v2, s[20:23], s36 offen sc1
    s_endpgm
k1_kepi:
    v_and_b32 v2, 0x13, v14
    v_and_b32 v3, 4, v14
    v_lshl_or_b32 v2, v3, 1, v2
    v_and_b32 v3, 8, v14
    v_lshrrev_b32 v3, 1, v3
    v_or_b32 v2, v2, v3
    v_lshlrev_b32 v2, 4, v2
    v_lshl_add_u32 v2, v15, 10, v2
    s_mul_i32 s35, s33, 131072
    s_mul_i32 s36, s34, 2048
    s_add_u32 s35, s35, s36
    s_add_u32 s35, s35, 2097152
    s_nop 5
    v_cvt_pk_bf16_f32 v16, v64, v65
    v_cvt_pk_bf16_f32 v17, v66, v67
    v_cvt_pk_bf16_f32 v18, v68, v69
    v_cvt_pk_bf16_f32 v19, v70, v71
    v_cvt_pk_bf16_f32 v20, v72, v73
    v_cvt_pk_bf16_f32 v21, v74, v75
    v_cvt_pk_bf16_f32 v22, v76, v77
    v_cvt_pk_bf16_f32 v23, v78, v79
    s_add_u32 s36, s35, 0
    buffer_store_dwordx4 v[16:19], v2, s[20:23], s36 offen sc1
    s_add_u32 s36, s35, 131072
    buffer_store_dwordx4 v[20:23], v2, s[20:23], s36 offen sc1
    v_cvt_pk_bf16_f32 v24, v80, v81
    v_cvt_pk_bf16_f32 v25, v82, v83
    v_cvt_pk_bf16_f32 v26, v84, v85
    v_cvt_pk_bf16_f32 v27, v86, v87
    v_cvt_pk_bf16_f32 v28, v88, v89
    v_cvt_pk_bf16_f32 v29, v90, v91
    v_cvt_pk_bf16_f32 v30, v92, v93
    v_cvt_pk_bf16_f32 v31, v94, v95
    s_add_u32 s36, s35, 2048
    buffer_store_dwordx4 v[24:27], v2, s[20:23], s36 offen sc1
    s_add_u32 s36, s35, 133120
    buffer_store_dwordx4 v[28:31], v2, s[20:23], s36 offen sc1
    v_cvt_pk_bf16_f32 v32, v96, v97
    v_cvt_pk_bf16_f32 v33, v98, v99
    v_cvt_pk_bf16_f32 v34, v100, v101
    v_cvt_pk_bf16_f32 v35, v102, v103
    v_cvt_pk_bf16_f32 v36, v104, v105
    v_cvt_pk_bf16_f32 v37, v106, v107
    v_cvt_pk_bf16_f32 v38, v108, v109
    v_cvt_pk_bf16_f32 v39, v110, v111
    s_add_u32 s36, s35, 262144
    buffer_store_dwordx4 v[32:35], v2, s[20:23], s36 offen sc1
    s_add_u32 s36, s35, 393216
    buffer_store_dwordx4 v[36:39], v2, s[20:23], s36 offen sc1
    v_cvt_pk_bf16_f32 v40, v112, v113
    v_cvt_pk_bf16_f32 v41, v114, v115
    v_cvt_pk_bf16_f32 v42, v116, v117
    v_cvt_pk_bf16_f32 v43, v118, v119
    v_cvt_pk_bf16_f32 v44, v120, v121
    v_cvt_pk_bf16_f32 v45, v122, v123
    v_cvt_pk_bf16_f32 v46, v124, v125
    v_cvt_pk_bf16_f32 v47, v126, v127
    s_add_u32 s36, s35, 264192
    buffer_store_dwordx4 v[40:43], v2, s[20:23], s36 offen sc1
    s_add_u32 s36, s35, 395264
    buffer_store_dwordx4 v[44:47], v2, s[20:23], s36 offen sc1
    v_pk_mul_f32 v[16:17], v[64:65], v[64:65]
    v_pk_mul_f32 v[18:19], v[72:73], v[72:73]
    v_pk_mul_f32 v[20:21], v[80:81], v[80:81]
    v_pk_mul_f32 v[22:23], v[88:89], v[88:89]
    v_pk_mul_f32 v[24:25], v[96:97], v[96:97]
    v_pk_mul_f32 v[26:27], v[104:105], v[104:105]
    v_pk_mul_f32 v[28:29], v[112:113], v[112:113]
    v_pk_mul_f32 v[30:31], v[120:121], v[120:121]
    v_pk_fma_f32 v[16:17], v[66:67], v[66:67], v[16:17]
    v_pk_fma_f32 v[18:19], v[74:75], v[74:75], v[18:19]
    v_pk_fma_f32 v[20:21], v[82:83], v[82:83], v[20:21]
    v_pk_fma_f32 v[22:23], v[90:91], v[90:91], v[22:23]
    v_pk_fma_f32 v[24:25], v[98:99], v[98:99], v[24:25]
    v_pk_fma_f32 v[26:27], v[106:107], v[106:107], v[26:27]
    v_pk_fma_f32 v[28:29], v[114:115], v[114:115], v[28:29]
    v_pk_fma_f32 v[30:31], v[122:123], v[122:123], v[30:31]
    v_pk_fma_f32 v[16:17], v[68:69], v[68:69], v[16:17]
    v_pk_fma_f32 v[18:19], v[76:77], v[76:77], v[18:19]
    v_pk_fma_f32 v[20:21], v[84:85], v[84:85], v[20:21]
    v_pk_fma_f32 v[22:23], v[92:93], v[92:93], v[22:23]
    v_pk_fma_f32 v[24:25], v[100:101], v[100:101], v[24:25]
    v_pk_fma_f32 v[26:27], v[108:109], v[108:109], v[26:27]
    v_pk_fma_f32 v[28:29], v[116:117], v[116:117], v[28:29]
    v_pk_fma_f32 v[30:31], v[124:125], v[124:125], v[30:31]
    v_pk_fma_f32 v[16:17], v[70:71], v[70:71], v[16:17]
    v_pk_fma_f32 v[18:19], v[78:79], v[78:79], v[18:19]
    v_pk_fma_f32 v[20:21], v[86:87], v[86:87], v[20:21]
    v_pk_fma_f32 v[22:23], v[94:95], v[94:95], v[22:23]
    v_pk_fma_f32 v[24:25], v[102:103], v[102:103], v[24:25]
    v_pk_fma_f32 v[26:27], v[110:111], v[110:111], v[26:27]
    v_pk_fma_f32 v[28:29], v[118:119], v[118:119], v[28:29]
    v_pk_fma_f32 v[30:31], v[126:127], v[126:127], v[30:31]
    v_add_f32 v48, v16, v17
    v_add_f32 v49, v18, v19
    v_add_f32 v50, v20, v21
    v_add_f32 v51, v22, v23
    v_add_f32 v52, v24, v25
    v_add_f32 v53, v26, v27
    v_add_f32 v54, v28, v29
    v_add_f32 v55, v30, v31
    s_nop 1
    v_permlane32_swap_b32 v48, v49
    v_permlane32_swap_b32 v50, v51
    v_permlane32_swap_b32 v52, v53
    v_permlane32_swap_b32 v54, v55
    s_nop 1
    v_add_f32 v48, v48, v49
    v_add_f32 v50, v50, v51
    v_add_f32 v52, v52, v53
    v_add_f32 v54, v54, v55
    v_max_f32_dpp v48, v48, v48 row_shr:1 row_mask:0xf bank_mask:0xf bound_ctrl:0
    v_max_f32_dpp v50, v50, v50 row_shr:1 row_mask:0xf bank_mask:0xf bound_ctrl:0
    v_max_f32_dpp v52, v52, v52 row_shr:1 row_mask:0xf bank_mask:0xf bound_ctrl:0
    v_max_f32_dpp v54, v54, v54 row_shr:1 row_mask:0xf bank_mask:0xf bound_ctrl:0
    v_max_f32_dpp v48, v48, v48 row_shr:2 row_mask:0xf bank_mask:0xf bound_ctrl:0
    v_max_f32_dpp v50, v50, v50 row_shr:2 row_mask:0xf bank_mask:0xf bound_ctrl:0
    v_max_f32_dpp v52, v52, v52 row_shr:2 row_mask:0xf bank_mask:0xf bound_ctrl:0
    v_max_f32_dpp v54, v54, v54 row_shr:2 row_mask:0xf bank_mask:0xf bound_ctrl:0
    v_max_f32_dpp v48, v48, v48 row_shr:4 row_mask:0xf bank_mask:0xf bound_ctrl:0
    v_max_f32_dpp v50, v50, v50 row_shr:4 row_mask:0xf bank_mask:0xf bound_ctrl:0
    v_max_f32_dpp v52, v52, v52 row_shr:4 row_mask:0xf bank_mask:0xf bound_ctrl:0
    v_max_f32_dpp v54, v54, v54 row_shr:4 row_mask:0xf bank_mask:0xf bound_ctrl:0
    v_max_f32_dpp v48, v48, v48 row_shr:8 row_mask:0xf bank_mask:0xf bound_ctrl:0
    v_max_f32_dpp v50, v50, v50 row_shr:8 row_mask:0xf bank_mask:0xf bound_ctrl:0
    v_max_f32_dpp v52, v52, v52 row_shr:8 row_mask:0xf bank_mask:0xf bound_ctrl:0
    v_max_f32_dpp v54, v54, v54 row_shr:8 row_mask:0xf bank_mask:0xf bound_ctrl:0
    v_max_f32_dpp v48, v48, v48 row_bcast:15 row_mask:0xa bank_mask:0xf
    v_max_f32_dpp v50, v50, v50 row_bcast:15 row_mask:0xa bank_mask:0xf
    v_max_f32_dpp v52, v52, v52 row_bcast:15 row_mask:0xa bank_mask:0xf
    v_max_f32_dpp v54, v54, v54 row_bcast:15 row_mask:0xa bank_mask:0xf
    v_lshlrev_b32 v3, 8, v15
    s_lshl_b32 s35, s33, 8
    s_lshl_b32 s36, s34, 2
    s_add_u32 s35, s35, s36
    s_add_u32 s35, s35, 6422528
    s_mov_b32 exec_lo, 0x80000000
    s_mov_b32 exec_hi, 0x80000000
    s_add_u32 s36, s35, 0
    buffer_store_dword v48, v3, s[20:23], s36 offen sc1
    s_add_u32 s36, s35, 4
    buffer_store_dword v50, v3, s[20:23], s36 offen sc1
    s_add_u32 s36, s35, 512
    buffer_store_dword v52, v3, s[20:23], s36 offen sc1
    s_add_u32 s36, s35, 516
    buffer_store_dword v54, v3, s[20:23], s36 offen sc1
    s_endpgm
k1_vloop:
    s_barrier
    ds_read_b128 v[16:19], v2 offset:0
    ds_read_b64_tr_b16 v[24:25], v10 offset:0
    ds_read_b64_tr_b16 v[26:27], v10 offset:1024
    ds_read_b128 v[20:23], v2 offset:4096
    ds_read_b64_tr_b16 v[28:29], v11 offset:0
    ds_read_b64_tr_b16 v[30:31], v11 offset:1024
    ds_read_b128 v[32:35], v3 offset:0
    ds_read_b64_tr_b16 v[40:41], v10 offset:4096
    ds_read_b64_tr_b16 v[42:43], v10 offset:5120
    ds_read_b128 v[36:39], v3 offset:4096
    ds_read_b64_tr_b16 v[44:45], v11 offset:4096
    ds_read_b64_tr_b16 v[46:47], v11 offset:5120
    s_waitcnt lgkmcnt(6)
    v_mfma_f32_32x32x16_bf16 v[64:79], v[16:19], v[24:27], v[64:79]
    v_mfma_f32_32x32x16_bf16 v[80:95], v[20:23], v[24:27], v[80:95]
    v_mfma_f32_32x32x16_bf16 v[96:111], v[16:19], v[28:31], v[96:111]
    v_mfma_f32_32x32x16_bf16 v[112:127], v[20:23], v[28:31], v[112:127]
    ds_read_b128 v[16:19], v4 offset:0
    ds_read_b64_tr_b16 v[24:25], v10 offset:8192
    ds_read_b64_tr_b16 v[26:27], v10 offset:9216
    ds_read_b128 v[20:23], v4 offset:4096
    ds_read_b64_tr_b16 v[28:29], v11 offset:8192
    ds_read_b64_tr_b16 v[30:31], v11 offset:9216
    s_waitcnt lgkmcnt(6)
    v_mfma_f32_32x32x16_bf16 v[64:79], v[32:35], v[40:43], v[64:79]
    v_mfma_f32_32x32x16_bf16 v[80:95], v[36:39], v[40:43], v[80:95]
    v_mfma_f32_32x32x16_bf16 v[96:111], v[32:35], v[44:47], v[96:111]
    v_mfma_f32_32x32x16_bf16 v[112:127], v[36:39], v[44:47], v[112:127]
    ds_read_b128 v[32:35], v5 offset:0
    ds_read_b64_tr_b16 v[40:41], v10 offset:12288
    ds_read_b64_tr_b16 v[42:43], v10 offset:13312
    ds_read_b128 v[36:39], v5 offset:4096
    ds_read_b64_tr_b16 v[44:45], v11 offset:12288
    ds_read_b64_tr_b16 v[46:47], v11 offset:13312
    s_waitcnt lgkmcnt(6)
    v_mfma_f32_32x32x16_bf16 v[64:79], v[16:19], v[24:27], v[64:79]
    v_mfma_f32_32x32x16_bf16 v[80:95], v[20:23], v[24:27], v[80:95]
    v_mfma_f32_32x32x16_bf16 v[96:111], v[16:19], v[28:31], v[96:111]
    v_mfma_f32_32x32x16_bf16 v[112:127], v[20:23], v[28:31], v[112:127]
    s_waitcnt lgkmcnt(0)
    s_barrier
    ds_read_b128 v[16:19], v2 offset:32768
    ds_read_b64_tr_b16 v[24:25], v10 offset:32768
    ds_read_b64_tr_b16 v[26:27], v10 offset:33792
    ds_read_b128 v[20:23], v2 offset:36864
    ds_read_b64_tr_b16 v[28:29], v11 offset:32768
    ds_read_b64_tr_b16 v[30:31], v11 offset:33792
    v_mfma_f32_32x32x16_bf16 v[64:79], v[32:35], v[40:43], v[64:79]
    v_mfma_f32_32x32x16_bf16 v[80:95], v[36:39], v[40:43], v[80:95]
    v_mfma_f32_32x32x16_bf16 v[96:111], v[32:35], v[44:47], v[96:111]
    v_mfma_f32_32x32x16_bf16 v[112:127], v[36:39], v[44:47], v[112:127]
    ds_read_b128 v[32:35], v3 offset:32768
    ds_read_b64_tr_b16 v[40:41], v10 offset:36864
    ds_read_b64_tr_b16 v[42:43], v10 offset:37888
    ds_read_b128 v[36:39], v3 offset:36864
    ds_read_b64_tr_b16 v[44:45], v11 offset:36864
    ds_read_b64_tr_b16 v[46:47], v11 offset:37888
    s_waitcnt lgkmcnt(6)
    v_mfma_f32_32x32x16_bf16 v[64:79], v[16:19], v[24:27], v[64:79]
    v_mfma_f32_32x32x16_bf16 v[80:95], v[20:23], v[24:27], v[80:95]
    v_mfma_f32_32x32x16_bf16 v[96:111], v[16:19], v[28:31], v[96:111]
    v_mfma_f32_32x32x16_bf16 v[112:127], v[20:23], v[28:31], v[112:127]
    ds_read_b128 v[16:19], v4 offset:32768
    ds_read_b64_tr_b16 v[24:25], v10 offset:40960
    ds_read_b64_tr_b16 v[26:27], v10 offset:41984
    ds_read_b128 v[20:23], v4 offset:36864
    ds_read_b64_tr_b16 v[28:29], v11 offset:40960
    ds_read_b64_tr_b16 v[30:31], v11 offset:41984
    s_waitcnt lgkmcnt(6)
    v_mfma_f32_32x32x16_bf16 v[64:79], v[32:35], v[40:43], v[64:79]
    v_mfma_f32_32x32x16_bf16 v[80:95], v[36:39], v[40:43], v[80:95]
    v_mfma_f32_32x32x16_bf16 v[96:111], v[32:35], v[44:47], v[96:111]
    v_mfma_f32_32x32x16_bf16 v[112:127], v[36:39], v[44:47], v[112:127]
    ds_read_b128 v[32:35], v5 offset:32768
    ds_read_b64_tr_b16 v[40:41], v10 offset:45056
    ds_read_b64_tr_b16 v[42:43], v10 offset:46080
    ds_read_b128 v[36:39], v5 offset:36864
    ds_read_b64_tr_b16 v[44:45], v11 offset:45056
    ds_read_b64_tr_b16 v[46:47], v11 offset:46080
    s_waitcnt lgkmcnt(6)
    v_mfma_f32_32x32x16_bf16 v[64:79], v[16:19], v[24:27], v[64:79]
    v_mfma_f32_32x32x16_bf16 v[80:95], v[20:23], v[24:27], v[80:95]
    v_mfma_f32_32x32x16_bf16 v[96:111], v[16:19], v[28:31], v[96:111]
    v_mfma_f32_32x32x16_bf16 v[112:127], v[20:23], v[28:31], v[112:127]
    s_waitcnt lgkmcnt(0)
    s_barrier
    ds_read_b128 v[16:19], v6 offset:0
    ds_read_b64_tr_b16 v[24:25], v12 offset:0
    ds_read_b64_tr_b16 v[26:27], v12 offset:1024
    ds_read_b128 v[20:23], v6 offset:4096
    ds_read_b64_tr_b16 v[28:29], v13 offset:0
    ds_read_b64_tr_b16 v[30:31], v13 offset:1024
    v_mfma_f32_32x32x16_bf16 v[64:79], v[32:35], v[40:43], v[64:79]
    v_mfma_f32_32x32x16_bf16 v[80:95], v[36:39], v[40:43], v[80:95]
    v_mfma_f32_32x32x16_bf16 v[96:111], v[32:35], v[44:47], v[96:111]
    v_mfma_f32_32x32x16_bf16 v[112:127], v[36:39], v[44:47], v[112:127]
    ds_read_b128 v[32:35], v7 offset:0
    ds_read_b64_tr_b16 v[40:41], v12 offset:4096
    ds_read_b64_tr_b16 v[42:43], v12 offset:5120
    ds_read_b128 v[36:39], v7 offset:4096
    ds_read_b64_tr_b16 v[44:45], v13 offset:4096
    ds_read_b64_tr_b16 v[46:47], v13 offset:5120
    s_waitcnt lgkmcnt(6)
    v_mfma_f32_32x32x16_bf16 v[64:79], v[16:19], v[24:27], v[64:79]
    v_mfma_f32_32x32x16_bf16 v[80:95], v[20:23], v[24:27], v[80:95]
    v_mfma_f32_32x32x16_bf16 v[96:111], v[16:19], v[28:31], v[96:111]
    v_mfma_f32_32x32x16_bf16 v[112:127], v[20:23], v[28:31], v[112:127]
    ds_read_b128 v[16:19], v8 offset:0
    ds_read_b64_tr_b16 v[24:25], v12 offset:8192
    ds_read_b64_tr_b16 v[26:27], v12 offset:9216
    ds_read_b128 v[20:23], v8 offset:4096
    ds_read_b64_tr_b16 v[28:29], v13 offset:8192
    ds_read_b64_tr_b16 v[30:31], v13 offset:9216
    s_waitcnt lgkmcnt(6)
    v_mfma_f32_32x32x16_bf16 v[64:79], v[32:35], v[40:43], v[64:79]
    v_mfma_f32_32x32x16_bf16 v[80:95], v[36:39], v[40:43], v[80:95]
    v_mfma_f32_32x32x16_bf16 v[96:111], v[32:35], v[44:47], v[96:111]
    v_mfma_f32_32x32x16_bf16 v[112:127], v[36:39], v[44:47], v[112:127]
    ds_read_b128 v[32:35], v9 offset:0
    ds_read_b64_tr_b16 v[40:41], v12 offset:12288
    ds_read_b64_tr_b16 v[42:43], v12 offset:13312
    ds_read_b128 v[36:39], v9 offset:4096
    ds_read_b64_tr_b16 v[44:45], v13 offset:12288
    ds_read_b64_tr_b16 v[46:47], v13 offset:13312
    s_waitcnt lgkmcnt(6)
    v_mfma_f32_32x32x16_bf16 v[64:79], v[16:19], v[24:27], v[64:79]
    v_mfma_f32_32x32x16_bf16 v[80:95], v[20:23], v[24:27], v[80:95]
    v_mfma_f32_32x32x16_bf16 v[96:111], v[16:19], v[28:31], v[96:111]
    v_mfma_f32_32x32x16_bf16 v[112:127], v[20:23], v[28:31], v[112:127]
    s_waitcnt lgkmcnt(0)
    s_barrier
    ds_read_b128 v[16:19], v6 offset:32768
    ds_read_b64_tr_b16 v[24:25], v12 offset:32768
    ds_read_b64_tr_b16 v[26:27], v12 offset:33792
    ds_read_b128 v[20:23], v6 offset:36864
    ds_read_b64_tr_b16 v[28:29], v13 offset:32768
    ds_read_b64_tr_b16 v[30:31], v13 offset:33792
    v_mfma_f32_32x32x16_bf16 v[64:79], v[32:35], v[40:43], v[64:79]
    v_mfma_f32_32x32x16_bf16 v[80:95], v[36:39], v[40:43], v[80:95]
    v_mfma_f32_32x32x16_bf16 v[96:111], v[32:35], v[44:47], v[96:111]
    v_mfma_f32_32x32x16_bf16 v[112:127], v[36:39], v[44:47], v[112:127]
    ds_read_b128 v[32:35], v7 offset:32768
    ds_read_b64_tr_b16 v[40:41], v12 offset:36864
    ds_read_b64_tr_b16 v[42:43], v12 offset:37888
    ds_read_b128 v[36:39], v7 offset:36864
    ds_read_b64_tr_b16 v[44:45], v13 offset:36864
    ds_read_b64_tr_b16 v[46:47], v13 offset:37888
    s_waitcnt lgkmcnt(6)
    v_mfma_f32_32x32x16_bf16 v[64:79], v[16:19], v[24:27], v[64:79]
    v_mfma_f32_32x32x16_bf16 v[80:95], v[20:23], v[24:27], v[80:95]
    v_mfma_f32_32x32x16_bf16 v[96:111], v[16:19], v[28:31], v[96:111]
    v_mfma_f32_32x32x16_bf16 v[112:127], v[20:23], v[28:31], v[112:127]
    ds_read_b128 v[16:19], v8 offset:32768
    ds_read_b64_tr_b16 v[24:25], v12 offset:40960
    ds_read_b64_tr_b16 v[26:27], v12 offset:41984
    ds_read_b128 v[20:23], v8 offset:36864
    ds_read_b64_tr_b16 v[28:29], v13 offset:40960
    ds_read_b64_tr_b16 v[30:31], v13 offset:41984
    s_waitcnt lgkmcnt(6)
    v_mfma_f32_32x32x16_bf16 v[64:79], v[32:35], v[40:43], v[64:79]
    v_mfma_f32_32x32x16_bf16 v[80:95], v[36:39], v[40:43], v[80:95]
    v_mfma_f32_32x32x16_bf16 v[96:111], v[32:35], v[44:47], v[96:111]
    v_mfma_f32_32x32x16_bf16 v[112:127], v[36:39], v[44:47], v[112:127]
    ds_read_b128 v[32:35], v9 offset:32768
    ds_read_b64_tr_b16 v[40:41], v12 offset:45056
    ds_read_b64_tr_b16 v[42:43], v12 offset:46080
    ds_read_b128 v[36:39], v9 offset:36864
    ds_read_b64_tr_b16 v[44:45], v13 offset:45056
    ds_read_b64_tr_b16 v[46:47], v13 offset:46080
    s_waitcnt lgkmcnt(6)
    v_mfma_f32_32x32x16_bf16 v[64:79], v[16:19], v[24:27], v[64:79]
    v_mfma_f32_32x32x16_bf16 v[80:95], v[20:23], v[24:27], v[80:95]
    v_mfma_f32_32x32x16_bf16 v[96:111], v[16:19], v[28:31], v[96:111]
    v_mfma_f32_32x32x16_bf16 v[112:127], v[20:23], v[28:31], v[112:127]
    s_waitcnt lgkmcnt(0)
    s_barrier
    ds_read_b128 v[16:19], v2 offset:0
    ds_read_b64_tr_b16 v[24:25], v10 offset:0
    ds_read_b64_tr_b16 v[26:27], v10 offset:1024
    ds_read_b128 v[20:23], v2 offset:4096
    ds_read_b64_tr_b16 v[28:29], v11 offset:0
    ds_read_b64_tr_b16 v[30:31], v11 offset:1024
    v_mfma_f32_32x32x16_bf16 v[64:79], v[32:35], v[40:43], v[64:79]
    v_mfma_f32_32x32x16_bf16 v[80:95], v[36:39], v[40:43], v[80:95]
    v_mfma_f32_32x32x16_bf16 v[96:111], v[32:35], v[44:47], v[96:111]
    v_mfma_f32_32x32x16_bf16 v[112:127], v[36:39], v[44:47], v[112:127]
    ds_read_b128 v[32:35], v3 offset:0
    ds_read_b64_tr_b16 v[40:41], v10 offset:4096
    ds_read_b64_tr_b16 v[42:43], v10 offset:5120
    ds_read_b128 v[36:39], v3 offset:4096
    ds_read_b64_tr_b16 v[44:45], v11 offset:4096
    ds_read_b64_tr_b16 v[46:47], v11 offset:5120
    s_waitcnt lgkmcnt(6)
    v_mfma_f32_32x32x16_bf16 v[64:79], v[16:19], v[24:27], v[64:79]
    v_mfma_f32_32x32x16_bf16 v[80:95], v[20:23], v[24:27], v[80:95]
    v_mfma_f32_32x32x16_bf16 v[96:111], v[16:19], v[28:31], v[96:111]
    v_mfma_f32_32x32x16_bf16 v[112:127], v[20:23], v[28:31], v[112:127]
    ds_read_b128 v[16:19], v4 offset:0
    ds_read_b64_tr_b16 v[24:25], v10 offset:8192
    ds_read_b64_tr_b16 v[26:27], v10 offset:9216
    ds_read_b128 v[20:23], v4 offset:4096
    ds_read_b64_tr_b16 v[28:29], v11 offset:8192
    ds_read_b64_tr_b16 v[30:31], v11 offset:9216
    s_waitcnt lgkmcnt(6)
    v_mfma_f32_32x32x16_bf16 v[64:79], v[32:35], v[40:43], v[64:79]
    v_mfma_f32_32x32x16_bf16 v[80:95], v[36:39], v[40:43], v[80:95]
    v_mfma_f32_32x32x16_bf16 v[96:111], v[32:35], v[44:47], v[96:111]
    v_mfma_f32_32x32x16_bf16 v[112:127], v[36:39], v[44:47], v[112:127]
    ds_read_b128 v[32:35], v5 offset:0
    ds_read_b64_tr_b16 v[40:41], v10 offset:12288
    ds_read_b64_tr_b16 v[42:43], v10 offset:13312
    ds_read_b128 v[36:39], v5 offset:4096
    ds_read_b64_tr_b16 v[44:45], v11 offset:12288
    ds_read_b64_tr_b16 v[46:47], v11 offset:13312
    s_waitcnt lgkmcnt(6)
    v_mfma_f32_32x32x16_bf16 v[64:79], v[16:19], v[24:27], v[64:79]
    v_mfma_f32_32x32x16_bf16 v[80:95], v[20:23], v[24:27], v[80:95]
    v_mfma_f32_32x32x16_bf16 v[96:111], v[16:19], v[28:31], v[96:111]
    v_mfma_f32_32x32x16_bf16 v[112:127], v[20:23], v[28:31], v[112:127]
    s_waitcnt lgkmcnt(0)
    s_barrier
    ds_read_b128 v[16:19], v2 offset:32768
    ds_read_b64_tr_b16 v[24:25], v10 offset:32768
    ds_read_b64_tr_b16 v[26:27], v10 offset:33792
    ds_read_b128 v[20:23], v2 offset:36864
    ds_read_b64_tr_b16 v[28:29], v11 offset:32768
    ds_read_b64_tr_b16 v[30:31], v11 offset:33792
    v_mfma_f32_32x32x16_bf16 v[64:79], v[32:35], v[40:43], v[64:79]
    v_mfma_f32_32x32x16_bf16 v[80:95], v[36:39], v[40:43], v[80:95]
    v_mfma_f32_32x32x16_bf16 v[96:111], v[32:35], v[44:47], v[96:111]
    v_mfma_f32_32x32x16_bf16 v[112:127], v[36:39], v[44:47], v[112:127]
    ds_read_b128 v[32:35], v3 offset:32768
    ds_read_b64_tr_b16 v[40:41], v10 offset:36864
    ds_read_b64_tr_b16 v[42:43], v10 offset:37888
    ds_read_b128 v[36:39], v3 offset:36864
    ds_read_b64_tr_b16 v[44:45], v11 offset:36864
    ds_read_b64_tr_b16 v[46:47], v11 offset:37888
    s_waitcnt lgkmcnt(6)
    v_mfma_f32_32x32x16_bf16 v[64:79], v[16:19], v[24:27], v[64:79]
    v_mfma_f32_32x32x16_bf16 v[80:95], v[20:23], v[24:27], v[80:95]
    v_mfma_f32_32x32x16_bf16 v[96:111], v[16:19], v[28:31], v[96:111]
    v_mfma_f32_32x32x16_bf16 v[112:127], v[20:23], v[28:31], v[112:127]
    ds_read_b128 v[16:19], v4 offset:32768
    ds_read_b64_tr_b16 v[24:25], v10 offset:40960
    ds_read_b64_tr_b16 v[26:27], v10 offset:41984
    ds_read_b128 v[20:23], v4 offset:36864
    ds_read_b64_tr_b16 v[28:29], v11 offset:40960
    ds_read_b64_tr_b16 v[30:31], v11 offset:41984
    s_waitcnt lgkmcnt(6)
    v_mfma_f32_32x32x16_bf16 v[64:79], v[32:35], v[40:43], v[64:79]
    v_mfma_f32_32x32x16_bf16 v[80:95], v[36:39], v[40:43], v[80:95]
    v_mfma_f32_32x32x16_bf16 v[96:111], v[32:35], v[44:47], v[96:111]
    v_mfma_f32_32x32x16_bf16 v[112:127], v[36:39], v[44:47], v[112:127]
    ds_read_b128 v[32:35], v5 offset:32768
    ds_read_b64_tr_b16 v[40:41], v10 offset:45056
    ds_read_b64_tr_b16 v[42:43], v10 offset:46080
    ds_read_b128 v[36:39], v5 offset:36864
    ds_read_b64_tr_b16 v[44:45], v11 offset:45056
    ds_read_b64_tr_b16 v[46:47], v11 offset:46080
    s_waitcnt lgkmcnt(6)
    v_mfma_f32_32x32x16_bf16 v[64:79], v[16:19], v[24:27], v[64:79]
    v_mfma_f32_32x32x16_bf16 v[80:95], v[20:23], v[24:27], v[80:95]
    v_mfma_f32_32x32x16_bf16 v[96:111], v[16:19], v[28:31], v[96:111]
    v_mfma_f32_32x32x16_bf16 v[112:127], v[20:23], v[28:31], v[112:127]
    s_waitcnt lgkmcnt(0)
    s_barrier
    ds_read_b128 v[16:19], v6 offset:0
    ds_read_b64_tr_b16 v[24:25], v12 offset:0
    ds_read_b64_tr_b16 v[26:27], v12 offset:1024
    ds_read_b128 v[20:23], v6 offset:4096
    ds_read_b64_tr_b16 v[28:29], v13 offset:0
    ds_read_b64_tr_b16 v[30:31], v13 offset:1024
    v_mfma_f32_32x32x16_bf16 v[64:79], v[32:35], v[40:43], v[64:79]
    v_mfma_f32_32x32x16_bf16 v[80:95], v[36:39], v[40:43], v[80:95]
    v_mfma_f32_32x32x16_bf16 v[96:111], v[32:35], v[44:47], v[96:111]
    v_mfma_f32_32x32x16_bf16 v[112:127], v[36:39], v[44:47], v[112:127]
    ds_read_b128 v[32:35], v7 offset:0
    ds_read_b64_tr_b16 v[40:41], v12 offset:4096
    ds_read_b64_tr_b16 v[42:43], v12 offset:5120
    ds_read_b128 v[36:39], v7 offset:4096
    ds_read_b64_tr_b16 v[44:45], v13 offset:4096
    ds_read_b64_tr_b16 v[46:47], v13 offset:5120
    s_waitcnt lgkmcnt(6)
    v_mfma_f32_32x32x16_bf16 v[64:79], v[16:19], v[24:27], v[64:79]
    v_mfma_f32_32x32x16_bf16 v[80:95], v[20:23], v[24:27], v[80:95]
    v_mfma_f32_32x32x16_bf16 v[96:111], v[16:19], v[28:31], v[96:111]
    v_mfma_f32_32x32x16_bf16 v[112:127], v[20:23], v[28:31], v[112:127]
    ds_read_b128 v[16:19], v8 offset:0
    ds_read_b64_tr_b16 v[24:25], v12 offset:8192
    ds_read_b64_tr_b16 v[26:27], v12 offset:9216
    ds_read_b128 v[20:23], v8 offset:4096
    ds_read_b64_tr_b16 v[28:29], v13 offset:8192
    ds_read_b64_tr_b16 v[30:31], v13 offset:9216
    s_waitcnt lgkmcnt(6)
    v_mfma_f32_32x32x16_bf16 v[64:79], v[32:35], v[40:43], v[64:79]
    v_mfma_f32_32x32x16_bf16 v[80:95], v[36:39], v[40:43], v[80:95]
    v_mfma_f32_32x32x16_bf16 v[96:111], v[32:35], v[44:47], v[96:111]
    v_mfma_f32_32x32x16_bf16 v[112:127], v[36:39], v[44:47], v[112:127]
    ds_read_b128 v[32:35], v9 offset:0
    ds_read_b64_tr_b16 v[40:41], v12 offset:12288
    ds_read_b64_tr_b16 v[42:43], v12 offset:13312
    ds_read_b128 v[36:39], v9 offset:4096
    ds_read_b64_tr_b16 v[44:45], v13 offset:12288
    ds_read_b64_tr_b16 v[46:47], v13 offset:13312
    s_waitcnt lgkmcnt(6)
    v_mfma_f32_32x32x16_bf16 v[64:79], v[16:19], v[24:27], v[64:79]
    v_mfma_f32_32x32x16_bf16 v[80:95], v[20:23], v[24:27], v[80:95]
    v_mfma_f32_32x32x16_bf16 v[96:111], v[16:19], v[28:31], v[96:111]
    v_mfma_f32_32x32x16_bf16 v[112:127], v[20:23], v[28:31], v[112:127]
    s_waitcnt lgkmcnt(0)
    s_barrier
    ds_read_b128 v[16:19], v6 offset:32768
    ds_read_b64_tr_b16 v[24:25], v12 offset:32768
    ds_read_b64_tr_b16 v[26:27], v12 offset:33792
    ds_read_b128 v[20:23], v6 offset:36864
    ds_read_b64_tr_b16 v[28:29], v13 offset:32768
    ds_read_b64_tr_b16 v[30:31], v13 offset:33792
    v_mfma_f32_32x32x16_bf16 v[64:79], v[32:35], v[40:43], v[64:79]
    v_mfma_f32_32x32x16_bf16 v[80:95], v[36:39], v[40:43], v[80:95]
    v_mfma_f32_32x32x16_bf16 v[96:111], v[32:35], v[44:47], v[96:111]
    v_mfma_f32_32x32x16_bf16 v[112:127], v[36:39], v[44:47], v[112:127]
    ds_read_b128 v[32:35], v7 offset:32768
    ds_read_b64_tr_b16 v[40:41], v12 offset:36864
    ds_read_b64_tr_b16 v[42:43], v12 offset:37888
    ds_read_b128 v[36:39], v7 offset:36864
    ds_read_b64_tr_b16 v[44:45], v13 offset:36864
    ds_read_b64_tr_b16 v[46:47], v13 offset:37888
    s_waitcnt lgkmcnt(6)
    v_mfma_f32_32x32x16_bf16 v[64:79], v[16:19], v[24:27], v[64:79]
    v_mfma_f32_32x32x16_bf16 v[80:95], v[20:23], v[24:27], v[80:95]
    v_mfma_f32_32x32x16_bf16 v[96:111], v[16:19], v[28:31], v[96:111]
    v_mfma_f32_32x32x16_bf16 v[112:127], v[20:23], v[28:31], v[112:127]
    ds_read_b128 v[16:19], v8 offset:32768
    ds_read_b64_tr_b16 v[24:25], v12 offset:40960
    ds_read_b64_tr_b16 v[26:27], v12 offset:41984
    ds_read_b128 v[20:23], v8 offset:36864
    ds_read_b64_tr_b16 v[28:29], v13 offset:40960
    ds_read_b64_tr_b16 v[30:31], v13 offset:41984
    s_waitcnt lgkmcnt(6)
    v_mfma_f32_32x32x16_bf16 v[64:79], v[32:35], v[40:43], v[64:79]
    v_mfma_f32_32x32x16_bf16 v[80:95], v[36:39], v[40:43], v[80:95]
    v_mfma_f32_32x32x16_bf16 v[96:111], v[32:35], v[44:47], v[96:111]
    v_mfma_f32_32x32x16_bf16 v[112:127], v[36:39], v[44:47], v[112:127]
    ds_read_b128 v[32:35], v9 offset:32768
    ds_read_b64_tr_b16 v[40:41], v12 offset:45056
    ds_read_b64_tr_b16 v[42:43], v12 offset:46080
    ds_read_b128 v[36:39], v9 offset:36864
    ds_read_b64_tr_b16 v[44:45], v13 offset:45056
    ds_read_b64_tr_b16 v[46:47], v13 offset:46080
    s_waitcnt lgkmcnt(6)
    v_mfma_f32_32x32x16_bf16 v[64:79], v[16:19], v[24:27], v[64:79]
    v_mfma_f32_32x32x16_bf16 v[80:95], v[20:23], v[24:27], v[80:95]
    v_mfma_f32_32x32x16_bf16 v[96:111], v[16:19], v[28:31], v[96:111]
    v_mfma_f32_32x32x16_bf16 v[112:127], v[20:23], v[28:31], v[112:127]
    s_waitcnt lgkmcnt(0)
    v_mfma_f32_32x32x16_bf16 v[64:79], v[32:35], v[40:43], v[64:79]
    v_mfma_f32_32x32x16_bf16 v[80:95], v[36:39], v[40:43], v[80:95]
    v_mfma_f32_32x32x16_bf16 v[96:111], v[32:35], v[44:47], v[96:111]
    v_mfma_f32_32x32x16_bf16 v[112:127], v[36:39], v[44:47], v[112:127]
    s_and_b32 s33, s29, 3
    s_lshl_b32 s33, s33, 3
    s_lshl_b32 s34, s31, 2
    s_add_u32 s33, s33, s34
    s_lshl_b32 s34, s28, 2
    s_lshl_b32 s35, s30, 1
    s_add_u32 s34, s34, s35
    v_lshrrev_b32 v2, 4, v14
    s_mov_b32 s36, 131072
    v_mul_lo_u32 v2, v2, s36
    v_lshl_add_u32 v2, v15, 10, v2
    v_and_b32 v3, 15, v14
    v_lshl_add_u32 v2, v3, 4, v2
    s_mul_i32 s35, s33, 131072
    s_mul_i32 s36, s34, 2048
    s_add_u32 s35, s35, s36
    s_add_u32 s35, s35, 2097664
    v_cvt_pk_bf16_f32 v16, v64, v65
    v_cvt_pk_bf16_f32 v17, v66, v67
    v_cvt_pk_bf16_f32 v18, v68, v69
    v_cvt_pk_bf16_f32 v19, v70, v71
    v_cvt_pk_bf16_f32 v20, v72, v73
    v_cvt_pk_bf16_f32 v21, v74, v75
    v_cvt_pk_bf16_f32 v22, v76, v77
    v_cvt_pk_bf16_f32 v23, v78, v79
    s_add_u32 s36, s35, 0
    buffer_store_dwordx4 v[16:19], v2, s[20:23], s36 offen sc1
    s_add_u32 s36, s35, 256
    buffer_store_dwordx4 v[20:23], v2, s[20:23], s36 offen sc1
    v_cvt_pk_bf16_f32 v24, v80, v81
    v_cvt_pk_bf16_f32 v25, v82, v83
    v_cvt_pk_bf16_f32 v26, v84, v85
    v_cvt_pk_bf16_f32 v27, v86, v87
    v_cvt_pk_bf16_f32 v28, v88, v89
    v_cvt_pk_bf16_f32 v29, v90, v91
    v_cvt_pk_bf16_f32 v30, v92, v93
    v_cvt_pk_bf16_f32 v31, v94, v95
    s_add_u32 s36, s35, 2048
    buffer_store_dwordx4 v[24:27], v2, s[20:23], s36 offen sc1
    s_add_u32 s36, s35, 2304
    buffer_store_dwordx4 v[28:31], v2, s[20:23], s36 offen sc1
    v_cvt_pk_bf16_f32 v32, v96, v97
    v_cvt_pk_bf16_f32 v33, v98, v99
    v_cvt_pk_bf16_f32 v34, v100, v101
    v_cvt_pk_bf16_f32 v35, v102, v103
    v_cvt_pk_bf16_f32 v36, v104, v105
    v_cvt_pk_bf16_f32 v37, v106, v107
    v_cvt_pk_bf16_f32 v38, v108, v109
    v_cvt_pk_bf16_f32 v39, v110, v111
    s_add_u32 s36, s35, 262144
    buffer_store_dwordx4 v[32:35], v2, s[20:23], s36 offen sc1
    s_add_u32 s36, s35, 262400
    buffer_store_dwordx4 v[36:39], v2, s[20:23], s36 offen sc1
    v_cvt_pk_bf16_f32 v40, v112, v113
    v_cvt_pk_bf16_f32 v41, v114, v115
    v_cvt_pk_bf16_f32 v42, v116, v117
    v_cvt_pk_bf16_f32 v43, v118, v119
    v_cvt_pk_bf16_f32 v44, v120, v121
    v_cvt_pk_bf16_f32 v45, v122, v123
    v_cvt_pk_bf16_f32 v46, v124, v125
    v_cvt_pk_bf16_f32 v47, v126, v127
    s_add_u32 s36, s35, 264192
    buffer_store_dwordx4 v[40:43], v2, s[20:23], s36 offen sc1
    s_add_u32 s36, s35, 264448
    buffer_store_dwordx4 v[44:47], v2, s[20:23], s36 offen sc1
    s_endpgm
k1_B:
    s_sub_u32 s18, s2, 192
    s_lshr_b32 s19, s18, 1
    s_and_b32 s28, s18, 1
    v_and_b32 v2, 15, v1
    v_lshrrev_b32 v3, 4, v1
    v_lshlrev_b32 v6, 4, v1
    s_waitcnt lgkmcnt(0)
    s_mov_b32 s20, s10
    s_and_b32 s21, s11, 0xffff
    s_mov_b32 s22, 2097152
    s_mov_b32 s23, 0x20000
    s_mov_b32 s24, s16
    s_and_b32 s25, s17, 0xffff
    s_mov_b32 s26, 268435456
    s_mov_b32 s27, 0x20000
    s_mov_b32 s44, s8
    s_and_b32 s45, s9, 0xffff
    s_mov_b32 s46, 524288
    s_mov_b32 s47, 0x20000
    s_and_b32 s35, s18, 7
    s_lshl_b32 s35, s35, 3
    s_add_u32 s35, s35, s3
    s_lshr_b32 s36, s18, 3
    s_and_b32 s37, s36, 3
    s_lshr_b32 s36, s36, 2
    s_lshl_b32 s36, s36, 2
    s_add_u32 s36, s36, s37
    s_lshl_b32 s36, s36, 8
    s_add_u32 s35, s35, s36
    s_mul_i32 s35, s35, 514
    v_and_b32 v144, 31, v1
    v_lshlrev_b32 v144, 4, v144
    v_add_u32 v144, s35, v144
    v_cmp_gt_u32 vcc, 32, v1
    v_mov_b32 v146, s14
    v_mov_b32 v147, s15
    v_mov_b32 v148, s12
    v_mov_b32 v149, s13
    v_cndmask_b32 v146, v146, v148, vcc
    v_cndmask_b32 v147, v147, v149, vcc
    v_add_co_u32 v146, vcc, v146, v144
    s_mul_i32 s36, s3, 4224
    s_nop 0
    v_addc_co_u32 v147, vcc, 0, v147, vcc
    s_add_u32 m0, s36, 66560
    s_nop 0
    global_load_lds_dwordx4 v[146:147], off
    v_add_co_u32 v146, vcc, 32896, v146
    s_nop 1
    v_addc_co_u32 v147, vcc, 0, v147, vcc
    s_add_u32 m0, s36, 67616
    s_nop 0
    global_load_lds_dwordx4 v[146:147], off
    v_add_co_u32 v146, vcc, 32896, v146
    s_nop 1
    v_addc_co_u32 v147, vcc, 0, v147, vcc
    s_add_u32 m0, s36, 68672
    s_nop 0
    global_load_lds_dwordx4 v[146:147], off
    v_add_co_u32 v146, vcc, 32896, v146
    s_nop 1
    v_addc_co_u32 v147, vcc, 0, v147, vcc
    s_add_u32 m0, s36, 69728
    s_nop 0
    global_load_lds_dwordx4 v[146:147], off
    v_cvt_f32_u32 v4, v2
    v_lshlrev_b32 v5, 2, v3
    v_cvt_f32_u32 v5, v5
    v_mul_f32 v144, 0x3d800000, v4
    v_mov_b32 v145, v5
    v_add_f32 v146, 1.0, v5
    v_add_f32 v147, 2.0, v5
    v_add_f32 v148, 3.0, v5
    v_mul_f32 v145, v145, v144
    v_mul_f32 v146, v146, v144
    v_mul_f32 v147, v147, v144
    v_mul_f32 v148, v148, v144
    v_cos_f32 v149, v145
    v_sin_f32 v153, v145
    v_cos_f32 v150, v146
    v_sin_f32 v154, v146
    v_cos_f32 v151, v147
    v_sin_f32 v155, v147
    v_cos_f32 v152, v148
    v_sin_f32 v156, v148
    s_nop 0
    v_cvt_pk_bf16_f32 v8, v149, v153
    v_cvt_pk_bf16_f32 v12, -v153, v149
    v_cvt_pk_bf16_f32 v9, v150, v154
    v_cvt_pk_bf16_f32 v13, -v154, v150
    v_cvt_pk_bf16_f32 v10, v151, v155
    v_cvt_pk_bf16_f32 v14, -v155, v151
    v_cvt_pk_bf16_f32 v11, v152, v156
    v_cvt_pk_bf16_f32 v15, -v156, v152
    v_mul_f32 v144, 0x3b000000, v4
    v_mov_b32 v145, v5
    v_add_f32 v146, 0x3f800000, v5
    v_add_f32 v147, 0x40000000, v5
    v_add_f32 v148, 0x40400000, v5
    v_add_f32 v149, 0x41800000, v5
    v_add_f32 v150, 0x41880000, v5
    v_add_f32 v151, 0x41900000, v5
    v_add_f32 v152, 0x41980000, v5
    v_mul_f32 v145, v145, v144
    v_mul_f32 v146, v146, v144
    v_mul_f32 v147, v147, v144
    v_mul_f32 v148, v148, v144
    v_mul_f32 v149, v149, v144
    v_mul_f32 v150, v150, v144
    v_mul_f32 v151, v151, v144
    v_mul_f32 v152, v152, v144
    v_cos_f32 v16, v145
    v_sin_f32 v24, v145
    v_cos_f32 v17, v146
    v_sin_f32 v25, v146
    v_cos_f32 v18, v147
    v_sin_f32 v26, v147
    v_cos_f32 v19, v148
    v_sin_f32 v27, v148
    v_cos_f32 v20, v149
    v_sin_f32 v28, v149
    v_cos_f32 v21, v150
    v_sin_f32 v29, v150
    v_cos_f32 v22, v151
    v_sin_f32 v30, v151
    v_cos_f32 v23, v152
    v_sin_f32 v31, v152
    v_mov_b32 v145, v5
    v_add_f32 v146, 0x3f800000, v5
    v_add_f32 v147, 0x40000000, v5
    v_add_f32 v148, 0x40400000, v5
    v_add_f32 v149, 0x41800000, v5
    v_add_f32 v150, 0x41880000, v5
    v_add_f32 v151, 0x41900000, v5
    v_add_f32 v152, 0x41980000, v5
    v_mul_f32 v153, 0x3d000000, v4
    v_add_f32 v154, 0.5, v153
    v_mul_f32 v155, v145, v153
    v_mul_f32 v156, v146, v153
    v_mul_f32 v157, v147, v153
    v_mul_f32 v158, v148, v153
    v_mul_f32 v159, v149, v153
    v_mul_f32 v160, v150, v153
    v_mul_f32 v161, v151, v153
    v_mul_f32 v162, v152, v153
    v_cos_f32 v163, v155
    v_sin_f32 v155, v155
    v_cos_f32 v164, v156
    v_sin_f32 v156, v156
    v_cos_f32 v165, v157
    v_sin_f32 v157, v157
    v_cos_f32 v166, v158
    v_sin_f32 v158, v158
    v_cos_f32 v167, v159
    v_sin_f32 v159, v159
    v_cos_f32 v168, v160
    v_sin_f32 v160, v160
    v_cos_f32 v169, v161
    v_sin_f32 v161, v161
    v_cos_f32 v170, v162
    v_sin_f32 v162, v162
    s_nop 0
    v_cvt_pk_bf16_f32 v32, v163, v155
    v_cvt_pk_bf16_f32 v40, -v155, v163
    v_cvt_pk_bf16_f32 v33, v164, v156
    v_cvt_pk_bf16_f32 v41, -v156, v164
    v_cvt_pk_bf16_f32 v34, v165, v157
    v_cvt_pk_bf16_f32 v42, -v157, v165
    v_cvt_pk_bf16_f32 v35, v166, v158
    v_cvt_pk_bf16_f32 v43, -v158, v166
    v_cvt_pk_bf16_f32 v36, v167, v159
    v_cvt_pk_bf16_f32 v44, -v159, v167
    v_cvt_pk_bf16_f32 v37, v168, v160
    v_cvt_pk_bf16_f32 v45, -v160, v168
    v_cvt_pk_bf16_f32 v38, v169, v161
    v_cvt_pk_bf16_f32 v46, -v161, v169
    v_cvt_pk_bf16_f32 v39, v170, v162
    v_cvt_pk_bf16_f32 v47, -v162, v170
    v_mul_f32 v155, v145, v154
    v_mul_f32 v156, v146, v154
    v_mul_f32 v157, v147, v154
    v_mul_f32 v158, v148, v154
    v_mul_f32 v159, v149, v154
    v_mul_f32 v160, v150, v154
    v_mul_f32 v161, v151, v154
    v_mul_f32 v162, v152, v154
    v_cos_f32 v163, v155
    v_sin_f32 v155, v155
    v_cos_f32 v164, v156
    v_sin_f32 v156, v156
    v_cos_f32 v165, v157
    v_sin_f32 v157, v157
    v_cos_f32 v166, v158
    v_sin_f32 v158, v158
    v_cos_f32 v167, v159
    v_sin_f32 v159, v159
    v_cos_f32 v168, v160
    v_sin_f32 v160, v160
    v_cos_f32 v169, v161
    v_sin_f32 v161, v161
    v_cos_f32 v170, v162
    v_sin_f32 v162, v162
    s_nop 0
    v_cvt_pk_bf16_f32 v48, v163, v155
    v_cvt_pk_bf16_f32 v56, -v155, v163
    v_cvt_pk_bf16_f32 v49, v164, v156
    v_cvt_pk_bf16_f32 v57, -v156, v164
    v_cvt_pk_bf16_f32 v50, v165, v157
    v_cvt_pk_bf16_f32 v58, -v157, v165
    v_cvt_pk_bf16_f32 v51, v166, v158
    v_cvt_pk_bf16_f32 v59, -v158, v166
    v_cvt_pk_bf16_f32 v52, v167, v159
    v_cvt_pk_bf16_f32 v60, -v159, v167
    v_cvt_pk_bf16_f32 v53, v168, v160
    v_cvt_pk_bf16_f32 v61, -v160, v168
    v_cvt_pk_bf16_f32 v54, v169, v161
    v_cvt_pk_bf16_f32 v62, -v161, v169
    v_cvt_pk_bf16_f32 v55, v170, v162
    v_cvt_pk_bf16_f32 v63, -v162, v170
    s_cmp_lt_u32 s18, 2
    s_cbranch_scc0 k1_B_not64
    s_lshl_b32 s36, s18, 3
    s_add_u32 s36, s36, s3
    s_lshr_b32 s37, s36, 2
    s_and_b32 s38, s36, 3
    s_lshl_b32 s37, s37, 4
    s_lshl_b32 s38, s38, 4
    v_add_u32 v144, s37, v2
    v_cvt_f32_u32 v144, v144
    v_mul_f32 v144, 0x3c800000, v144
    v_cvt_f32_u32 v145, s38
    v_add_f32 v145, v145, v5
    v_add_f32 v146, 1.0, v145
    v_add_f32 v147, 2.0, v145
    v_add_f32 v148, 1.0, v147
    v_mul_f32 v145, v145, v144
    v_mul_f32 v146, v146, v144
    v_mul_f32 v147, v147, v144
    v_mul_f32 v148, v148, v144
    v_cos_f32 v149, v145
    v_sin_f32 v153, v145
    v_cos_f32 v150, v146
    v_sin_f32 v154, v146
    v_cos_f32 v151, v147
    v_sin_f32 v155, v147
    v_cos_f32 v152, v148
    v_sin_f32 v156, v148
    s_nop 0
    v_cvt_pk_bf16_f32 v160, v149, v153
    v_cvt_pk_bf16_f32 v164, -v153, v149
    v_cvt_pk_bf16_f32 v161, v150, v154
    v_cvt_pk_bf16_f32 v165, -v154, v150
    v_cvt_pk_bf16_f32 v162, v151, v155
    v_cvt_pk_bf16_f32 v166, -v155, v151
    v_cvt_pk_bf16_f32 v163, v152, v156
    v_cvt_pk_bf16_f32 v167, -v156, v152
    s_lshl_b32 s36, s36, 11
    s_add_u32 s36, s36, 13303808
    buffer_store_dwordx4 v[160:163], v6, s[24:27], s36 offen sc1
    buffer_store_dwordx4 v[164:167], v6, s[24:27], s36 offen offset:1024 sc1
k1_B_not64:
    s_cmp_eq_u32 s18, 2
    s_cbranch_scc0 k1_B_notw
    s_cmp_lt_u32 s3, 4
    s_cbranch_scc0 k1_B_a32
    s_lshl_b32 s37, s3, 4
    v_add_u32 v144, s37, v2
    v_cvt_f32_u32 v144, v144
    v_mul_f32 v144, 0x3a000000, v144
    v_mov_b32 v145, v5
    v_add_f32 v146, 0x3f800000, v5
    v_add_f32 v147, 0x40000000, v5
    v_add_f32 v148, 0x40400000, v5
    v_add_f32 v149, 0x41800000, v5
    v_add_f32 v150, 0x41880000, v5
    v_add_f32 v151, 0x41900000, v5
    v_add_f32 v152, 0x41980000, v5
    v_mul_f32 v145, v145, v144
    v_mul_f32 v146, v146, v144
    v_mul_f32 v147, v147, v144
    v_mul_f32 v148, v148, v144
    v_mul_f32 v149, v149, v144
    v_mul_f32 v150, v150, v144
    v_mul_f32 v151, v151, v144
    v_mul_f32 v152, v152, v144
    v_cos_f32 v160, v145
    v_sin_f32 v168, v145
    v_cos_f32 v161, v146
    v_sin_f32 v169, v146
    v_cos_f32 v162, v147
    v_sin_f32 v170, v147
    v_cos_f32 v163, v148
    v_sin_f32 v171, v148
    v_cos_f32 v164, v149
    v_sin_f32 v172, v149
    v_cos_f32 v165, v150
    v_sin_f32 v173, v150
    v_cos_f32 v166, v151
    v_sin_f32 v174, v151
    v_cos_f32 v167, v152
    v_sin_f32 v175, v152
    s_lshl_b32 s36, s3, 12
    s_add_u32 s36, s36, 13344768
    buffer_store_dwordx4 v[160:163], v6, s[24:27], s36 offen sc1
    buffer_store_dwordx4 v[164:167], v6, s[24:27], s36 offen offset:1024 sc1
    buffer_store_dwordx4 v[168:171], v6, s[24:27], s36 offen offset:2048 sc1
    buffer_store_dwordx4 v[172:175], v6, s[24:27], s36 offen offset:3072 sc1
    s_branch k1_B_notw
k1_B_a32:
    s_cmp_eq_u32 s3, 4
    s_cbranch_scc0 k1_B_notw
    s_mov_b32 s36, 13336576
    buffer_store_dwordx4 v[32:35], v6, s[24:27], s36 offen sc1
    s_mov_b32 s36, 13337600
    buffer_store_dwordx4 v[36:39], v6, s[24:27], s36 offen sc1
    s_mov_b32 s36, 13338624
    buffer_store_dwordx4 v[40:43], v6, s[24:27], s36 offen sc1
    s_mov_b32 s36, 13339648
    buffer_store_dwordx4 v[44:47], v6, s[24:27], s36 offen sc1
    s_mov_b32 s36, 13340672
    buffer_store_dwordx4 v[48:51], v6, s[24:27], s36 offen sc1
    s_mov_b32 s36, 13341696
    buffer_store_dwordx4 v[52:55], v6, s[24:27], s36 offen sc1
    s_mov_b32 s36, 13342720
    buffer_store_dwordx4 v[56:59], v6, s[24:27], s36 offen sc1
    s_mov_b32 s36, 13343744
    buffer_store_dwordx4 v[60:63], v6, s[24:27], s36 offen sc1
k1_B_notw:
    s_waitcnt vmcnt(0)
    s_lshl_b32 s29, s28, 5
    s_lshl_b32 s30, s3, 2
    s_add_u32 s29, s29, s30
    s_lshl_b32 s29, s29, 5
    s_add_u32 s29, s29, s19
    s_lshl_b32 s29, s29, 10
    s_mul_i32 s30, s3, 4224
    s_add_u32 m0, s30, 0
    s_add_u32 s31, s29, 0
    buffer_load_dwordx4 v6, s[20:23], s31 offen lds
    s_add_u32 m0, s30, 1056
    s_add_u32 s31, s29, 32768
    buffer_load_dwordx4 v6, s[20:23], s31 offen lds
    s_add_u32 m0, s30, 2112
    s_add_u32 s31, s29, 65536
    buffer_load_dwordx4 v6, s[20:23], s31 offen lds
    s_add_u32 m0, s30, 3168
    s_add_u32 s31, s29, 98304
    buffer_load_dwordx4 v6, s[20:23], s31 offen lds
    s_lshl_b32 s58, s18, 3
    s_add_u32 s58, s58, s3
    s_lshr_b32 s33, s58, 5
    s_lshl_b32 s33, s33, 6
    s_and_b32 s34, s58, 31
    s_lshl_b32 s34, s34, 14
    s_add_u32 s33, s33, s34
    v_and_b32 v7, 31, v1
    v_lshlrev_b32 v7, 1, v7
    v_lshrrev_b32 v144, 5, v1
    v_lshl_add_u32 v7, v144, 12, v7
    s_add_u32 s34, s33, 0
    buffer_load_ushort v192, v7, s[44:47], s34 offen
    s_add_u32 s34, s33, 1024
    buffer_load_ushort v196, v7, s[44:47], s34 offen
    s_add_u32 s34, s33, 2048
    buffer_load_ushort v193, v7, s[44:47], s34 offen
    s_add_u32 s34, s33, 3072
    buffer_load_ushort v197, v7, s[44:47], s34 offen
    s_add_u32 s34, s33, 8192
    buffer_load_ushort v194, v7, s[44:47], s34 offen
    s_add_u32 s34, s33, 9216
    buffer_load_ushort v198, v7, s[44:47], s34 offen
    s_add_u32 s34, s33, 10240
    buffer_load_ushort v195, v7, s[44:47], s34 offen
    s_add_u32 s34, s33, 11264
    buffer_load_ushort v199, v7, s[44:47], s34 offen
    s_sub_u32 s35, s18, 32
    s_cmp_lt_u32 s35, 32
    s_cselect_b32 s39, 1, 0
    s_cmp_eq_u32 s3, 7
    s_cselect_b32 s39, s39, 0
    s_cmp_eq_u32 s39, 1
    s_cbranch_scc0 k1_B_noab
    s_lshl_b32 s36, s35, 6
    v_add_u32 v144, s36, v1
    v_sub_u32 v145, 2048, v144
    v_and_b32 v145, 2047, v145
    v_mul_u32_u24 v144, 514, v144
    v_mul_u32_u24 v145, 514, v145
    s_mov_b32 s48, s12
    s_and_b32 s49, s13, 0xffff
    s_mov_b32 s50, 1052672
    s_mov_b32 s51, 0x20000
    s_mov_b32 s40, s14
    s_and_b32 s41, s15, 0xffff
    s_mov_b32 s42, 1052672
    s_mov_b32 s43, 0x20000
    buffer_load_ushort v200, v144, s[48:51], 0 offen offset:0
    buffer_load_ushort v201, v144, s[40:43], 0 offen offset:0
    buffer_load_ushort v202, v145, s[48:51], 0 offen offset:0
    buffer_load_ushort v203, v145, s[40:43], 0 offen offset:0
    buffer_load_ushort v204, v144, s[48:51], 0 offen offset:512
    buffer_load_ushort v205, v144, s[40:43], 0 offen offset:512
    buffer_load_ushort v206, v145, s[48:51], 0 offen offset:512
    buffer_load_ushort v207, v145, s[40:43], 0 offen offset:512
k1_B_noab:
    v_bfe_u32 v144, v1, 2, 2
    v_lshrrev_b32 v145, 1, v144
    v_mul_u32_u24 v145, 1056, v145
    v_and_b32 v146, 1, v144
    v_lshl_add_u32 v145, v146, 9, v145
    v_lshl_add_u32 v145, v3, 5, v145
    v_and_b32 v146, 3, v1
    v_lshl_add_u32 v145, v146, 3, v145
    s_mul_i32 s30, s3, 4224
    s_add_u32 s30, s30, 66560
    v_add_u32 v145, s30, v145
    ds_read_b64_tr_b16 v[80:81], v145 offset:0
    ds_read_b64_tr_b16 v[82:83], v145 offset:2112
    ds_read_b64_tr_b16 v[84:85], v145 offset:128
    ds_read_b64_tr_b16 v[86:87], v145 offset:2240
    ds_read_b64_tr_b16 v[88:89], v145 offset:256
    ds_read_b64_tr_b16 v[90:91], v145 offset:2368
    ds_read_b64_tr_b16 v[92:93], v145 offset:384
    ds_read_b64_tr_b16 v[94:95], v145 offset:2496
    v_and_b32 v146, 7, v1
    v_xor_b32 v146, s3, v146
    v_lshlrev_b32 v146, 4, v146
    v_lshl_add_u32 v146, v1, 7, v146
    v_add_u32 v146, 100352, v146
    s_waitcnt lgkmcnt(6)
    ds_write_b128 v146, v[80:83] offset:0
    s_waitcnt lgkmcnt(4)
    ds_write_b128 v146, v[84:87] offset:8192
    s_waitcnt lgkmcnt(2)
    ds_write_b128 v146, v[88:91] offset:16384
    s_waitcnt lgkmcnt(0)
    ds_write_b128 v146, v[92:95] offset:24576
    s_waitcnt lgkmcnt(0)
    s_barrier
    v_lshrrev_b32 v144, 3, v1
    v_and_b32 v145, 7, v1
    s_lshl_b32 s30, s3, 5
    v_add_u32 v146, s30, v144
    v_xor_b32 v147, v144, v145
    v_lshlrev_b32 v147, 4, v147
    v_lshl_add_u32 v147, v146, 7, v147
    v_add_u32 v147, 100352, v147
    v_lshlrev_b32 v149, 13, v146
    v_lshl_add_u32 v149, v145, 4, v149
    s_and_b32 s31, s18, 7
    s_lshr_b32 s32, s31, 1
    s_lshl_b32 s32, s32, 11
    s_and_b32 s31, s31, 1
    s_lshl_b32 s31, s31, 7
    s_add_u32 s32, s32, s31
    s_lshr_b32 s31, s18, 5
    s_lshl_b32 s31, s31, 10
    s_add_u32 s32, s32, s31
    s_lshr_b32 s31, s18, 3
    s_and_b32 s31, s31, 3
    s_lshl_b32 s31, s31, 8
    s_add_u32 s32, s32, s31
    s_add_u32 s32, s32, 13631488
    ds_read_b128 v[80:83], v147 offset:0
    ds_read_b128 v[84:87], v147 offset:1024
    ds_read_b128 v[88:91], v147 offset:2048
    ds_read_b128 v[92:95], v147 offset:3072
    s_waitcnt lgkmcnt(3)
    s_add_u32 s31, s32, 0
    buffer_store_dwordx4 v[80:83], v149, s[24:27], s31 offen sc1
    s_waitcnt lgkmcnt(2)
    s_add_u32 s31, s32, 65536
    buffer_store_dwordx4 v[84:87], v149, s[24:27], s31 offen sc1
    s_waitcnt lgkmcnt(1)
    s_add_u32 s31, s32, 131072
    buffer_store_dwordx4 v[88:91], v149, s[24:27], s31 offen sc1
    s_waitcnt lgkmcnt(0)
    s_add_u32 s31, s32, 196608
    buffer_store_dwordx4 v[92:95], v149, s[24:27], s31 offen sc1
    v_bfe_u32 v144, v1, 2, 2
    v_and_b32 v145, 1, v144
    v_mul_u32_u24 v145, 1056, v145
    v_lshrrev_b32 v146, 1, v144
    v_lshl_add_u32 v146, v3, 2, v146
    v_lshl_add_u32 v145, v146, 6, v145
    v_and_b32 v146, 3, v1
    v_lshl_add_u32 v145, v146, 3, v145
    s_mul_i32 s30, s3, 4224
    v_add_u32 v7, s30, v145
    s_waitcnt vmcnt(4)
    ds_read_b64_tr_b16 v[64:65], v7 offset:0
    ds_read_b64_tr_b16 v[66:67], v7 offset:128
    ds_read_b64_tr_b16 v[68:69], v7 offset:32
    ds_read_b64_tr_b16 v[70:71], v7 offset:160
    ds_read_b64_tr_b16 v[72:73], v7 offset:2112
    ds_read_b64_tr_b16 v[74:75], v7 offset:2240
    ds_read_b64_tr_b16 v[76:77], v7 offset:2144
    ds_read_b64_tr_b16 v[78:79], v7 offset:2272
    v_lshl_or_b32 v192, v196, 16, v192
    v_lshl_or_b32 v193, v197, 16, v193
    v_lshl_or_b32 v194, v198, 16, v194
    v_lshl_or_b32 v195, v199, 16, v195
    s_lshl_b32 s58, s58, 10
    s_add_u32 s58, s58, 12779520
    buffer_store_dwordx4 v[192:195], v6, s[24:27], s58 offen sc1
    s_cmp_eq_u32 s39, 1
    s_cbranch_scc0 k1_B_noab2
    v_lshlrev_b32 v200, 16, v200
    v_lshlrev_b32 v201, 16, v201
    v_lshlrev_b32 v202, 16, v202
    v_lshlrev_b32 v203, 16, v203
    v_lshlrev_b32 v204, 16, v204
    v_lshlrev_b32 v205, 16, v205
    v_lshlrev_b32 v206, 16, v206
    v_lshlrev_b32 v207, 16, v207
    v_add_f32 v144, v200, v202
    v_sub_f32 v145, v201, v203
    v_add_f32 v146, v204, v206
    v_sub_f32 v147, v205, v207
    v_add_f32 v148, v144, v146
    v_add_f32 v149, v145, v147
    v_sub_f32 v150, v144, v146
    v_sub_f32 v151, v145, v147
    v_mul_f32 v148, 0.25, v148
    v_mul_f32 v149, 0.25, v149
    v_mul_f32 v150, 0.25, v150
    v_mul_f32 v151, 0.25, v151
    v_cvt_pk_bf16_f32 v148, v148, v149
    v_cvt_pk_bf16_f32 v149, v150, v151
    s_lshr_b32 s36, s35, 4
    s_lshl_b32 s36, s36, 2
    s_and_b32 s37, s35, 3
    s_add_u32 s36, s36, s37
    s_and_b32 s38, s36, 1
    s_lshl_b32 s38, s38, 3
    s_lshr_b32 s36, s36, 1
    s_lshl_b32 s36, s36, 10
    s_add_u32 s36, s36, s38
    s_lshr_b32 s37, s35, 2
    s_and_b32 s37, s37, 3
    s_lshl_b32 s37, s37, 8
    s_add_u32 s36, s36, s37
    s_add_u32 s36, s36, 13361152
    v_lshlrev_b32 v152, 12, v3
    v_lshl_add_u32 v152, v2, 4, v152
    buffer_store_dwordx2 v[148:149], v152, s[24:27], s36 offen sc1
k1_B_noab2:
    s_waitcnt lgkmcnt(0)
    v_mfma_f32_16x16x32_bf16 v[80:83], v[64:67], v[8:11], 0
    v_mfma_f32_16x16x32_bf16 v[84:87], v[64:67], v[12:15], 0
    v_mfma_f32_16x16x32_bf16 v[88:91], v[68:71], v[8:11], 0
    v_mfma_f32_16x16x32_bf16 v[92:95], v[68:71], v[12:15], 0
    v_mfma_f32_16x16x32_bf16 v[96:99], v[72:75], v[8:11], 0
    v_mfma_f32_16x16x32_bf16 v[100:103], v[72:75], v[12:15], 0
    v_mfma_f32_16x16x32_bf16 v[104:107], v[76:79], v[8:11], 0
    v_mfma_f32_16x16x32_bf16 v[108:111], v[76:79], v[12:15], 0
    s_nop 4
    v_pk_mul_f32 v[144:145], v[80:81], v[16:17]
    v_pk_mul_f32 v[148:149], v[84:85], v[16:17]
    v_pk_mul_f32 v[146:147], v[82:83], v[18:19]
    v_pk_mul_f32 v[150:151], v[86:87], v[18:19]
    v_pk_fma_f32 v[144:145], v[84:85], v[24:25], v[144:145]
    v_pk_fma_f32 v[148:149], v[80:81], v[24:25], v[148:149] neg_lo:[1,0,0] neg_hi:[1,0,0]
    v_pk_fma_f32 v[146:147], v[86:87], v[26:27], v[146:147]
    v_pk_fma_f32 v[150:151], v[82:83], v[26:27], v[150:151] neg_lo:[1,0,0] neg_hi:[1,0,0]
    v_cvt_pk_bf16_f32 v64, v144, v148
    v_cvt_pk_bf16_f32 v65, v145, v149
    v_cvt_pk_bf16_f32 v66, v146, v150
    v_cvt_pk_bf16_f32 v67, v147, v151
    v_pk_mul_f32 v[144:145], v[88:89], v[20:21]
    v_pk_mul_f32 v[148:149], v[92:93], v[20:21]
    v_pk_mul_f32 v[146:147], v[90:91], v[22:23]
    v_pk_mul_f32 v[150:151], v[94:95], v[22:23]
    v_pk_fma_f32 v[144:145], v[92:93], v[28:29], v[144:145]
    v_pk_fma_f32 v[148:149], v[88:89], v[28:29], v[148:149] neg_lo:[1,0,0] neg_hi:[1,0,0]
    v_pk_fma_f32 v[146:147], v[94:95], v[30:31], v[146:147]
    v_pk_fma_f32 v[150:151], v[90:91], v[30:31], v[150:151] neg_lo:[1,0,0] neg_hi:[1,0,0]
    v_cvt_pk_bf16_f32 v68, v144, v148
    v_cvt_pk_bf16_f32 v69, v145, v149
    v_cvt_pk_bf16_f32 v70, v146, v150
    v_cvt_pk_bf16_f32 v71, v147, v151
    v_pk_mul_f32 v[144:145], v[96:97], v[16:17]
    v_pk_mul_f32 v[148:149], v[100:101], v[16:17]
    v_pk_mul_f32 v[146:147], v[98:99], v[18:19]
    v_pk_mul_f32 v[150:151], v[102:103], v[18:19]
    v_pk_fma_f32 v[144:145], v[100:101], v[24:25], v[144:145]
    v_pk_fma_f32 v[148:149], v[96:97], v[24:25], v[148:149] neg_lo:[1,0,0] neg_hi:[1,0,0]
    v_pk_fma_f32 v[146:147], v[102:103], v[26:27], v[146:147]
    v_pk_fma_f32 v[150:151], v[98:99], v[26:27], v[150:151] neg_lo:[1,0,0] neg_hi:[1,0,0]
    v_cvt_pk_bf16_f32 v72, v144, v148
    v_cvt_pk_bf16_f32 v73, v145, v149
    v_cvt_pk_bf16_f32 v74, v146, v150
    v_cvt_pk_bf16_f32 v75, v147, v151
    v_pk_mul_f32 v[144:145], v[104:105], v[20:21]
    v_pk_mul_f32 v[148:149], v[108:109], v[20:21]
    v_pk_mul_f32 v[146:147], v[106:107], v[22:23]
    v_pk_mul_f32 v[150:151], v[110:111], v[22:23]
    v_pk_fma_f32 v[144:145], v[108:109], v[28:29], v[144:145]
    v_pk_fma_f32 v[148:149], v[104:105], v[28:29], v[148:149] neg_lo:[1,0,0] neg_hi:[1,0,0]
    v_pk_fma_f32 v[146:147], v[110:111], v[30:31], v[146:147]
    v_pk_fma_f32 v[150:151], v[106:107], v[30:31], v[150:151] neg_lo:[1,0,0] neg_hi:[1,0,0]
    v_cvt_pk_bf16_f32 v76, v144, v148
    v_cvt_pk_bf16_f32 v77, v145, v149
    v_cvt_pk_bf16_f32 v78, v146, v150
    v_cvt_pk_bf16_f32 v79, v147, v151
    s_nop 1
    v_mfma_f32_16x16x32_bf16 v[112:115], v[32:35], v[64:67], 0
    v_mfma_f32_16x16x32_bf16 v[112:115], v[36:39], v[68:71], v[112:115]
    v_mfma_f32_16x16x32_bf16 v[116:119], v[40:43], v[64:67], 0
    v_mfma_f32_16x16x32_bf16 v[116:119], v[44:47], v[68:71], v[116:119]
    v_mfma_f32_16x16x32_bf16 v[120:123], v[48:51], v[64:67], 0
    v_mfma_f32_16x16x32_bf16 v[120:123], v[52:55], v[68:71], v[120:123]
    v_mfma_f32_16x16x32_bf16 v[124:127], v[56:59], v[64:67], 0
    v_mfma_f32_16x16x32_bf16 v[124:127], v[60:63], v[68:71], v[124:127]
    v_mfma_f32_16x16x32_bf16 v[128:131], v[32:35], v[72:75], 0
    v_mfma_f32_16x16x32_bf16 v[128:131], v[36:39], v[76:79], v[128:131]
    v_mfma_f32_16x16x32_bf16 v[132:135], v[40:43], v[72:75], 0
    v_mfma_f32_16x16x32_bf16 v[132:135], v[44:47], v[76:79], v[132:135]
    v_mfma_f32_16x16x32_bf16 v[136:139], v[48:51], v[72:75], 0
    v_mfma_f32_16x16x32_bf16 v[136:139], v[52:55], v[76:79], v[136:139]
    v_mfma_f32_16x16x32_bf16 v[140:143], v[56:59], v[72:75], 0
    v_mfma_f32_16x16x32_bf16 v[140:143], v[60:63], v[76:79], v[140:143]
    v_lshl_add_u32 v144, v3, 6, v2
    s_mul_i32 s30, s3, 4224
    v_lshl_add_u32 v145, v144, 3, s30
    v_sub_u32 v146, 208, v144
    v_lshl_add_u32 v146, v146, 3, s30
    v_add_u32 v147, 384, v146
    v_cmp_eq_u32 vcc, 0, v1
    v_mov_b32 v148, s30
    s_nop 0
    v_cndmask_b32 v147, v147, v148, vcc
    s_nop 1
    ds_write2_b32 v145, v120, v124 offset0:0 offset1:1
    ds_write2_b32 v145, v121, v125 offset0:32 offset1:33
    ds_write2_b32 v145, v122, v126 offset0:64 offset1:65
    ds_write2_b32 v145, v123, v127 offset0:96 offset1:97
    v_add_u32 v149, 2048, v145
    ds_write2_b32 v149, v136, v140 offset0:0 offset1:1
    ds_write2_b32 v149, v137, v141 offset0:32 offset1:33
    ds_write2_b32 v149, v138, v142 offset0:64 offset1:65
    ds_write2_b32 v149, v139, v143 offset0:96 offset1:97
    s_waitcnt lgkmcnt(0)
    ds_read_b64 v[80:81], v147 offset:0
    ds_read_b64 v[82:83], v146 offset:256
    ds_read_b64 v[84:85], v146 offset:128
    ds_read_b64 v[86:87], v146 offset:0
    ds_read_b64 v[88:89], v147 offset:2048
    ds_read_b64 v[90:91], v146 offset:2304
    ds_read_b64 v[92:93], v146 offset:2176
    ds_read_b64 v[94:95], v146 offset:2048
    v_lshrrev_b32 v150, 1, v2
    v_xor_b32 v150, s3, v150
    v_lshlrev_b32 v150, 4, v150
    v_lshl_add_u32 v150, v144, 7, v150
    v_add_u32 v150, 33792, v150
    s_waitcnt lgkmcnt(0)
    v_add_f32 v152, v112, v80
    v_sub_f32 v153, v116, v81
    v_add_f32 v154, v116, v81
    v_sub_f32 v155, v80, v112
    v_add_f32 v156, v112, v112
    v_add_f32 v157, v80, v80
    v_add_f32 v158, v116, v116
    v_add_f32 v159, v81, v81
    v_cndmask_b32 v152, v152, v156, vcc
    v_cndmask_b32 v153, v153, v157, vcc
    v_cndmask_b32 v154, v154, v158, vcc
    v_cndmask_b32 v155, v155, v159, vcc
    v_cvt_pk_bf16_f32 v160, v152, v153
    v_cvt_pk_bf16_f32 v161, v154, v155
    ds_write_b64 v150, v[160:161] offset:0
    v_add_f32 v152, v113, v82
    v_sub_f32 v153, v117, v83
    v_add_f32 v154, v117, v83
    v_sub_f32 v155, v82, v113
    v_cvt_pk_bf16_f32 v162, v152, v153
    v_cvt_pk_bf16_f32 v163, v154, v155
    ds_write_b64 v150, v[162:163] offset:2048
    v_add_f32 v152, v114, v84
    v_sub_f32 v153, v118, v85
    v_add_f32 v154, v118, v85
    v_sub_f32 v155, v84, v114
    v_cvt_pk_bf16_f32 v164, v152, v153
    v_cvt_pk_bf16_f32 v165, v154, v155
    ds_write_b64 v150, v[164:165] offset:4096
    v_add_f32 v152, v115, v86
    v_sub_f32 v153, v119, v87
    v_add_f32 v154, v119, v87
    v_sub_f32 v155, v86, v115
    v_cvt_pk_bf16_f32 v166, v152, v153
    v_cvt_pk_bf16_f32 v167, v154, v155
    ds_write_b64 v150, v[166:167] offset:6144
    v_add_f32 v152, v128, v88
    v_sub_f32 v153, v132, v89
    v_add_f32 v154, v132, v89
    v_sub_f32 v155, v88, v128
    v_add_f32 v156, v128, v128
    v_add_f32 v157, v88, v88
    v_add_f32 v158, v132, v132
    v_add_f32 v159, v89, v89
    v_cndmask_b32 v152, v152, v156, vcc
    v_cndmask_b32 v153, v153, v157, vcc
    v_cndmask_b32 v154, v154, v158, vcc
    v_cndmask_b32 v155, v155, v159, vcc
    v_cvt_pk_bf16_f32 v160, v152, v153
    v_cvt_pk_bf16_f32 v161, v154, v155
    ds_write_b64 v150, v[160:161] offset:8
    v_add_f32 v152, v129, v90
    v_sub_f32 v153, v133, v91
    v_add_f32 v154, v133, v91
    v_sub_f32 v155, v90, v129
    v_cvt_pk_bf16_f32 v162, v152, v153
    v_cvt_pk_bf16_f32 v163, v154, v155
    ds_write_b64 v150, v[162:163] offset:2056
    v_add_f32 v152, v130, v92
    v_sub_f32 v153, v134, v93
    v_add_f32 v154, v134, v93
    v_sub_f32 v155, v92, v130
    v_cvt_pk_bf16_f32 v164, v152, v153
    v_cvt_pk_bf16_f32 v165, v154, v155
    ds_write_b64 v150, v[164:165] offset:4104
    v_add_f32 v152, v131, v94
    v_sub_f32 v153, v135, v95
    v_add_f32 v154, v135, v95
    v_sub_f32 v155, v94, v131
    v_cvt_pk_bf16_f32 v166, v152, v153
    v_cvt_pk_bf16_f32 v167, v154, v155
    ds_write_b64 v150, v[166:167] offset:6152
    s_waitcnt lgkmcnt(0)
    s_barrier
    v_lshrrev_b32 v144, 3, v1
    v_and_b32 v145, 7, v1
    s_lshl_b32 s30, s3, 5
    v_add_u32 v146, s30, v144
    v_lshrrev_b32 v147, 1, v144
    v_xor_b32 v147, v147, v145
    v_lshlrev_b32 v147, 4, v147
    v_lshl_add_u32 v147, v146, 7, v147
    v_add_u32 v147, 33792, v147
    v_xor_b32 v148, 64, v147
    v_lshlrev_b32 v149, 13, v146
    v_lshl_add_u32 v149, v145, 4, v149
    s_lshl_b32 s31, s19, 8
    s_lshl_b32 s32, s28, 7
    s_add_u32 s31, s31, s32
    s_add_u32 s31, s31, 6488064
    ds_read_b128 v[112:115], v147 offset:0
    ds_read_b128 v[116:119], v148 offset:1024
    ds_read_b128 v[120:123], v147 offset:2048
    ds_read_b128 v[124:127], v148 offset:3072
    s_waitcnt lgkmcnt(3)
    s_add_u32 s32, s31, 0
    buffer_store_dwordx4 v[112:115], v149, s[24:27], s32 offen sc1
    s_waitcnt lgkmcnt(2)
    s_add_u32 s32, s31, 65536
    buffer_store_dwordx4 v[116:119], v149, s[24:27], s32 offen sc1
    s_waitcnt lgkmcnt(1)
    s_add_u32 s32, s31, 131072
    buffer_store_dwordx4 v[120:123], v149, s[24:27], s32 offen sc1
    s_waitcnt lgkmcnt(0)
    s_add_u32 s32, s31, 196608
    buffer_store_dwordx4 v[124:127], v149, s[24:27], s32 offen sc1
    s_endpgm
k1_end:
    s_endpgm

.section .rodata,"a"
.p2align 6
.amdhsa_kernel qkv_rowfft_kernel
  .amdhsa_next_free_vgpr 256
  .amdhsa_next_free_sgpr 102
  .amdhsa_accum_offset 256
  .amdhsa_group_segment_fixed_size 0
  .amdhsa_kernarg_size 72
  .amdhsa_user_sgpr_count 2
  .amdhsa_user_sgpr_kernarg_segment_ptr 1
  .amdhsa_system_sgpr_workgroup_id_x 1
.end_amdhsa_kernel
.text
.globl attn_proj_kernel
.p2align 8
.type attn_proj_kernel,@function
attn_proj_kernel:
    s_cmp_ge_u32 s2, 256
    s_cbranch_scc1 k2_end
    s_load_dwordx2 s[16:17], s[0:1], 64
    s_load_dwordx4 s[52:55], s[0:1], 48
    v_and_b32 v1, 63, v0
    v_lshrrev_b32 v104, 6, v0
    s_nop 0
    v_readfirstlane_b32 s3, v104
    s_and_b32 s18, s2, 7
    s_lshr_b32 s19, s2, 3
    s_lshl_b32 s29, s18, 2
    s_and_b32 s30, s19, 3
    s_add_u32 s29, s29, s30
    s_lshr_b32 s30, s19, 2
    s_lshl_b32 s28, s18, 5
    s_add_u32 s28, s28, s19
    v_lshlrev_b32 v104, 4, v1
    s_and_b32 s33, s3, 3
    s_lshl_b32 s31, s30, 3
    s_lshl_b32 s33, s33, 1
    s_add_u32 s31, s31, s33
    s_mov_b32 s47, 0
    s_waitcnt lgkmcnt(0)
    s_mov_b32 s20, s16
    s_and_b32 s21, s17, 0xffff
    s_mov_b32 s22, 268435456
    s_mov_b32 s23, 0x20000
    s_cmp_ge_u32 s3, 8
    s_cbranch_scc1 k4_C
    s_lshl_b32 s32, s29, 16
    s_lshl_b32 s33, s31, 10
    s_add_u32 s32, s32, s33
    s_add_u32 s32, s32, 0
    buffer_load_dwordx4 v[8:11], v104, s[20:23], s32 offen
    buffer_load_dwordx4 v[12:15], v104, s[20:23], s32 offen offset:1024
    v_lshlrev_b32 v105, 2, v1
    s_lshl_b32 s32, s29, 8
    s_add_u32 s32, s32, 6422528
    buffer_load_dword v106, v105, s[20:23], s32 offen
    s_barrier
    v_mov_b32 v48, 0
    v_mov_b32 v49, 0
    v_mov_b32 v50, 0
    v_mov_b32 v51, 0
    v_mov_b32 v52, 0
    v_mov_b32 v53, 0
    v_mov_b32 v54, 0
    v_mov_b32 v55, 0
    v_mov_b32 v56, 0
    v_mov_b32 v57, 0
    v_mov_b32 v58, 0
    v_mov_b32 v59, 0
    v_mov_b32 v60, 0
    v_mov_b32 v61, 0
    v_mov_b32 v62, 0
    v_mov_b32 v63, 0
    v_mov_b32 v64, 0
    v_mov_b32 v65, 0
    v_mov_b32 v66, 0
    v_mov_b32 v67, 0
    v_mov_b32 v68, 0
    v_mov_b32 v69, 0
    v_mov_b32 v70, 0
    v_mov_b32 v71, 0
    v_mov_b32 v72, 0
    v_mov_b32 v73, 0
    v_mov_b32 v74, 0
    v_mov_b32 v75, 0
    v_mov_b32 v76, 0
    v_mov_b32 v77, 0
    v_mov_b32 v78, 0
    v_mov_b32 v79, 0
    v_mov_b32 v40, 0
    v_mov_b32 v41, 0
    v_mov_b32 v42, 0
    v_mov_b32 v43, 0
    v_mov_b32 v44, 0
    v_mov_b32 v45, 0
    v_mov_b32 v46, 0
    v_mov_b32 v47, 0
    v_and_b32 v107, 31, v1
    v_lshrrev_b32 v108, 5, v1
    v_lshlrev_b32 v108, 10, v108
    v_lshl_add_u32 v2, v107, 4, v108
    s_lshr_b32 s36, s3, 2
    s_lshl_b32 s36, s36, 16
    v_add_u32 v2, s36, v2
    v_cmp_eq_u32 vcc, 16, v107
    v_mov_b32 v108, 0x3f803f80
    v_mov_b32 v4, 0xdddd
    v_cndmask_b32 v108, 0, v108, vcc
    s_mov_b32 s62, 0xffff
    s_mov_b32 s63, 0xffff
    v_mov_b32 v84, v108
    v_mov_b32 v85, v108
    v_mov_b32 v86, v108
    v_mov_b32 v87, v108
    v_mov_b32 v88, v108
    v_mov_b32 v89, v108
    v_mov_b32 v90, v108
    v_mov_b32 v91, v108
    v_mov_b32 v96, v108
    v_mov_b32 v97, v108
    v_mov_b32 v98, v108
    v_mov_b32 v99, v108
    v_mov_b32 v100, v108
    v_mov_b32 v101, v108
    v_mov_b32 v102, v108
    v_mov_b32 v103, v108
    s_waitcnt vmcnt(0)
    v_lshlrev_b32 v107, 16, v8
    v_and_b32 v108, 0xffff0000, v8
    v_mul_f32 v109, v107, v107
    v_fmac_f32 v109, v108, v108
    v_lshlrev_b32 v107, 16, v9
    v_and_b32 v108, 0xffff0000, v9
    v_fmac_f32 v109, v107, v107
    v_fmac_f32 v109, v108, v108
    v_lshlrev_b32 v107, 16, v10
    v_and_b32 v108, 0xffff0000, v10
    v_fmac_f32 v109, v107, v107
    v_fmac_f32 v109, v108, v108
    v_lshlrev_b32 v107, 16, v11
    v_and_b32 v108, 0xffff0000, v11
    v_fmac_f32 v109, v107, v107
    v_fmac_f32 v109, v108, v108
    v_lshlrev_b32 v107, 16, v12
    v_and_b32 v108, 0xffff0000, v12
    v_mul_f32 v110, v107, v107
    v_fmac_f32 v110, v108, v108
    v_lshlrev_b32 v107, 16, v13
    v_and_b32 v108, 0xffff0000, v13
    v_fmac_f32 v110, v107, v107
    v_fmac_f32 v110, v108, v108
    v_lshlrev_b32 v107, 16, v14
    v_and_b32 v108, 0xffff0000, v14
    v_fmac_f32 v110, v107, v107
    v_fmac_f32 v110, v108, v108
    v_lshlrev_b32 v107, 16, v15
    v_and_b32 v108, 0xffff0000, v15
    v_fmac_f32 v110, v107, v107
    v_fmac_f32 v110, v108, v108
    s_nop 1
    v_permlane32_swap_b32 v109, v110
    s_nop 1
    v_add_f32 v109, v109, v110
    s_nop 0
    v_max_f32_dpp v106, v106, v106 row_shr:1 row_mask:0xf bank_mask:0xf bound_ctrl:0
    v_max_f32_dpp v109, v109, v109 row_shr:1 row_mask:0xf bank_mask:0xf bound_ctrl:0
    s_nop 0
    v_max_f32_dpp v106, v106, v106 row_shr:2 row_mask:0xf bank_mask:0xf bound_ctrl:0
    v_max_f32_dpp v109, v109, v109 row_shr:2 row_mask:0xf bank_mask:0xf bound_ctrl:0
    s_nop 0
    v_max_f32_dpp v106, v106, v106 row_shr:4 row_mask:0xf bank_mask:0xf bound_ctrl:0
    v_max_f32_dpp v109, v109, v109 row_shr:4 row_mask:0xf bank_mask:0xf bound_ctrl:0
    s_nop 0
    v_max_f32_dpp v106, v106, v106 row_shr:8 row_mask:0xf bank_mask:0xf bound_ctrl:0
    v_max_f32_dpp v109, v109, v109 row_shr:8 row_mask:0xf bank_mask:0xf bound_ctrl:0
    s_nop 0
    v_max_f32_dpp v106, v106, v106 row_bcast:15 row_mask:0xa bank_mask:0xf
    v_max_f32_dpp v109, v109, v109 row_bcast:15 row_mask:0xa bank_mask:0xf
    s_nop 0
    v_max_f32_dpp v106, v106, v106 row_bcast:31 row_mask:0xc bank_mask:0xf
    v_max_f32_dpp v109, v109, v109 row_bcast:31 row_mask:0xc bank_mask:0xf
    s_nop 0
    v_mul_f32 v106, v106, v109
    s_nop 0
    v_readlane_b32 s38, v106, 63
    s_cmp_lt_u32 s3, 4
    s_cbranch_scc1 k4_prioL
    s_setprio 1
    s_branch k4_priod
k4_prioL:
    s_setprio 2
k4_priod:
    v_mov_b32 v104, 163780
k4_cw1:
    ds_read_b32 v105, v104
    s_waitcnt lgkmcnt(0)
    v_readfirstlane_b32 s48, v105
    s_nop 0
    s_cmp_ge_u32 s48, 4
    s_cbranch_scc1 k4_cw1_ok
    s_sleep 1
    s_branch k4_cw1
k4_cw1_ok:
    s_cmp_le_u32 s38, 0x45788b2f
    s_cbranch_scc0 k4_fallback
    s_mov_b32 s57, 0
    ds_read_b128 v[80:83], v2
    s_mov_b64 exec, s[62:63]
    ds_read_b128 v[84:87], v2 offset:512
    ds_read_b128 v[88:91], v2 offset:768
    s_mov_b64 exec, -1
    s_waitcnt lgkmcnt(2)
    v_mfma_f32_32x32x16_bf16 v[16:31], v[80:83], v[8:11], 0
    s_mov_b32 s42, 0
    s_waitcnt lgkmcnt(0)
    s_nop 11
    s_mov_b32 s43, 1
    s_mov_b32 s41, 0
    s_cmp_lt_u32 s3, 4
    s_cselect_b32 s40, 6, 99
.p2align 6
k4_lean:
    v_exp_f32 v16, v16
    v_exp_f32 v17, v17
    v_smfmac_f32_32x32x32_bf16 v[64:79], v[100:103], v[40:47], v4
    ds_read_b128 v[92:95], v2 offset:2048
    v_exp_f32 v18, v18
    v_exp_f32 v19, v19
    v_exp_f32 v20, v20
    v_mfma_f32_32x32x16_bf16 v[32:47], v[80:83], v[12:15], 0
    v_exp_f32 v21, v21
    v_exp_f32 v22, v22
    s_mov_b64 exec, s[62:63]
    ds_read_b128 v[96:99], v2 offset:2560
    ds_read_b128 v[100:103], v2 offset:2816
    s_mov_b64 exec, -1
    v_exp_f32 v23, v23
    v_exp_f32 v24, v24
    v_exp_f32 v25, v25
    v_exp_f32 v26, v26
    v_exp_f32 v27, v27
    v_smfmac_f32_32x32x32_bf16 v[48:63], v[84:87], v[16:23], v4
    v_exp_f32 v28, v28
    v_exp_f32 v29, v29
    v_exp_f32 v30, v30
    v_exp_f32 v31, v31
    v_exp_f32 v32, v32
    v_exp_f32 v33, v33
    v_smfmac_f32_32x32x32_bf16 v[48:63], v[88:91], v[24:31], v4
    v_exp_f32 v34, v34
    v_exp_f32 v35, v35
    v_exp_f32 v36, v36
    s_waitcnt lgkmcnt(0)
    v_mfma_f32_32x32x16_bf16 v[16:31], v[92:95], v[8:11], 0
    v_exp_f32_e64 v37, v37
    v_exp_f32 v38, v38
    v_exp_f32 v39, v39
    v_exp_f32 v40, v40
    v_exp_f32 v41, v41
    v_exp_f32 v42, v42
    v_exp_f32 v43, v43
    v_smfmac_f32_32x32x32_bf16 v[64:79], v[84:87], v[32:39], v4
    v_exp_f32 v44, v44
    v_exp_f32 v45, v45
    v_exp_f32 v46, v46
    v_exp_f32 v47, v47
    v_exp_f32 v16, v16
    v_exp_f32 v17, v17
    v_smfmac_f32_32x32x32_bf16 v[64:79], v[88:91], v[40:47], v4
    ds_read_b128 v[80:83], v2 offset:4096
    v_exp_f32 v18, v18
    v_exp_f32 v19, v19
    v_exp_f32 v20, v20
    v_mfma_f32_32x32x16_bf16 v[32:47], v[92:95], v[12:15], 0
    v_exp_f32 v21, v21
    v_exp_f32 v22, v22
    s_mov_b64 exec, s[62:63]
    ds_read_b128 v[84:87], v2 offset:4608
    ds_read_b128 v[88:91], v2 offset:4864
    s_mov_b64 exec, -1
    v_exp_f32 v23, v23
    v_exp_f32 v24, v24
    v_exp_f32 v25, v25
    v_exp_f32 v26, v26
    v_exp_f32 v27, v27
    v_smfmac_f32_32x32x32_bf16 v[48:63], v[96:99], v[16:23], v4
    v_exp_f32 v28, v28
    v_exp_f32 v29, v29
    v_exp_f32 v30, v30
    v_exp_f32 v31, v31
    v_exp_f32 v32, v32
    v_exp_f32 v33, v33
    v_smfmac_f32_32x32x32_bf16 v[48:63], v[100:103], v[24:31], v4
    v_exp_f32 v34, v34
    v_exp_f32 v35, v35
    v_exp_f32 v36, v36
    s_waitcnt lgkmcnt(0)
    v_mfma_f32_32x32x16_bf16 v[16:31], v[80:83], v[8:11], 0
    v_exp_f32_e64 v37, v37
    v_exp_f32 v38, v38
    v_exp_f32 v39, v39
    v_exp_f32 v40, v40
    v_exp_f32 v41, v41
    v_exp_f32 v42, v42
    v_exp_f32 v43, v43
    v_smfmac_f32_32x32x32_bf16 v[64:79], v[96:99], v[32:39], v4
    v_exp_f32 v44, v44
    v_exp_f32 v45, v45
    v_exp_f32 v46, v46
    v_exp_f32 v47, v47
    v_exp_f32 v16, v16
    v_exp_f32 v17, v17
    v_smfmac_f32_32x32x32_bf16 v[64:79], v[100:103], v[40:47], v4
    ds_read_b128 v[92:95], v2 offset:6144
    v_exp_f32 v18, v18
    v_exp_f32 v19, v19
    v_exp_f32 v20, v20
    v_mfma_f32_32x32x16_bf16 v[32:47], v[80:83], v[12:15], 0
    v_exp_f32 v21, v21
    v_exp_f32 v22, v22
    s_mov_b64 exec, s[62:63]
    ds_read_b128 v[96:99], v2 offset:6656
    ds_read_b128 v[100:103], v2 offset:6912
    s_mov_b64 exec, -1
    v_exp_f32 v23, v23
    v_exp_f32 v24, v24
    v_exp_f32 v25, v25
    v_exp_f32 v26, v26
    v_exp_f32 v27, v27
    v_smfmac_f32_32x32x32_bf16 v[48:63], v[84:87], v[16:23], v4
    v_exp_f32 v28, v28
    v_exp_f32 v29, v29
    v_exp_f32 v30, v30
    v_exp_f32 v31, v31
    v_exp_f32 v32, v32
    v_exp_f32 v33, v33
    v_smfmac_f32_32x32x32_bf16 v[48:63], v[88:91], v[24:31], v4
    v_exp_f32 v34, v34
    v_exp_f32 v35, v35
    v_exp_f32 v36, v36
    s_waitcnt lgkmcnt(0)
    v_mfma_f32_32x32x16_bf16 v[16:31], v[92:95], v[8:11], 0
    v_exp_f32_e64 v37, v37
    v_exp_f32 v38, v38
    v_exp_f32 v39, v39
    v_exp_f32 v40, v40
    v_exp_f32 v41, v41
    v_exp_f32 v42, v42
    v_exp_f32 v43, v43
    v_smfmac_f32_32x32x32_bf16 v[64:79], v[84:87], v[32:39], v4
    v_exp_f32 v44, v44
    v_exp_f32 v45, v45
    v_exp_f32 v46, v46
    v_exp_f32 v47, v47
    v_exp_f32 v16, v16
    v_exp_f32 v17, v17
    v_smfmac_f32_32x32x32_bf16 v[64:79], v[88:91], v[40:47], v4
    ds_read_b128 v[80:83], v2 offset:8192
    v_exp_f32 v18, v18
    v_exp_f32 v19, v19
    v_exp_f32 v20, v20
    v_mfma_f32_32x32x16_bf16 v[32:47], v[92:95], v[12:15], 0
    v_exp_f32 v21, v21
    v_exp_f32 v22, v22
    s_mov_b64 exec, s[62:63]
    ds_read_b128 v[84:87], v2 offset:8704
    ds_read_b128 v[88:91], v2 offset:8960
    s_mov_b64 exec, -1
    v_exp_f32 v23, v23
    v_exp_f32 v24, v24
    v_exp_f32 v25, v25
    v_exp_f32 v26, v26
    v_exp_f32 v27, v27
    v_smfmac_f32_32x32x32_bf16 v[48:63], v[96:99], v[16:23], v4
    v_exp_f32 v28, v28
    v_exp_f32 v29, v29
    v_exp_f32 v30, v30
    v_exp_f32 v31, v31
    v_exp_f32 v32, v32
    v_exp_f32 v33, v33
    v_smfmac_f32_32x32x32_bf16 v[48:63], v[100:103], v[24:31], v4
    v_exp_f32 v34, v34
    v_exp_f32 v35, v35
    v_exp_f32 v36, v36
    s_waitcnt lgkmcnt(0)
    v_mfma_f32_32x32x16_bf16 v[16:31], v[80:83], v[8:11], 0
    v_exp_f32_e64 v37, v37
    v_exp_f32 v38, v38
    v_exp_f32 v39, v39
    v_exp_f32 v40, v40
    v_exp_f32 v41, v41
    v_exp_f32 v42, v42
    v_exp_f32 v43, v43
    v_smfmac_f32_32x32x32_bf16 v[64:79], v[96:99], v[32:39], v4
    v_exp_f32 v44, v44
    v_exp_f32 v45, v45
    v_exp_f32 v46, v46
    v_exp_f32 v47, v47
    v_add_u32 v2, 8192, v2
    s_add_u32 s42, s42, 1
    s_sub_u32 s43, s43, 1
    s_cmp_lg_u32 s43, 0
    s_cbranch_scc1 k4_lean
    s_add_u32 s41, s41, 1
    s_cmp_eq_u32 s41, 1
    s_cbranch_scc1 k4_seg1
    s_cmp_eq_u32 s41, 2
    s_cbranch_scc1 k4_seg2
    s_cmp_eq_u32 s41, 3
    s_cbranch_scc1 k4_seg3
k4_tail:
    v_mov_b32 v104, 163800
    v_mov_b32 v105, 1
    s_mov_b64 exec, 1
    ds_add_u32 v104, v105
    s_mov_b64 exec, -1
    s_nop 1
    v_smfmac_f32_32x32x32_bf16 v[64:79], v[100:103], v[40:47], v4
    s_setprio 0
    s_cmp_eq_u32 s57, 0
    s_cbranch_scc1 k4_stgok
    v_mov_b32 v104, 163796
k4_cw2:
    ds_read_b32 v105, v104
    s_waitcnt lgkmcnt(0)
    v_readfirstlane_b32 s48, v105
    s_nop 0
    s_cmp_ge_u32 s48, 1
    s_cbranch_scc1 k4_cw2_ok
    s_sleep 1
    s_branch k4_cw2
k4_cw2_ok:
k4_stgok:
    s_mul_i32 s36, s3, 2304
    s_add_u32 s37, s36, 140544
    s_add_u32 s36, s36, 131072
    s_cmp_lt_u32 s3, 3
    s_cselect_b32 s36, s36, s37
    s_xor_b32 s44, s3, 4
    s_mul_i32 s45, s44, 2304
    s_add_u32 s46, s45, 140544
    s_add_u32 s45, s45, 131072
    s_cmp_lt_u32 s44, 3
    s_cselect_b32 s45, s45, s46
    v_lshlrev_b32 v104, 4, v1
    v_lshlrev_b32 v105, 2, v1
    v_add_u32 v106, s36, v104
    v_add_u32 v107, s36, v105
    v_add_u32 v108, s45, v104
    v_add_u32 v109, s45, v105
    s_cmp_lt_u32 s3, 4
    s_cbranch_scc1 k4_tailL
    s_nop 9
    ds_write_b128 v106, v[48:51]
    ds_write_b128 v106, v[52:55] offset:1024
    ds_write_b32 v107, v56 offset:2048
    s_nop 7
    v_mov_b32 v48, v64
    v_mov_b32 v49, v65
    v_mov_b32 v50, v66
    v_mov_b32 v51, v67
    v_mov_b32 v52, v68
    v_mov_b32 v53, v69
    v_mov_b32 v54, v70
    v_mov_b32 v55, v71
    v_mov_b32 v56, v72
    s_add_u32 s31, s31, 1
    s_branch k4_tail2
k4_tailL:
    s_nop 15
    s_nop 3
    ds_write_b128 v106, v[64:67]
    ds_write_b128 v106, v[68:71] offset:1024
    ds_write_b32 v107, v72 offset:2048
k4_tail2:
    s_waitcnt lgkmcnt(0)
    s_lshl_b32 s36, s3, 2
    s_add_u32 s36, s36, 163808
    v_mov_b32 v110, s36
    v_mov_b32 v111, 1
    ds_write_b32 v110, v111
    s_lshl_b32 s36, s44, 2
    s_add_u32 s36, s36, 163808
    v_mov_b32 v110, s36
k4_cw3:
    ds_read_b32 v111, v110
    s_waitcnt lgkmcnt(0)
    v_readfirstlane_b32 s48, v111
    s_nop 0
    s_cmp_ge_u32 s48, 1
    s_cbranch_scc1 k4_cw3_ok
    s_branch k4_cw3
k4_cw3_ok:
    ds_read_b128 v[16:19], v108
    ds_read_b128 v[20:23], v108 offset:1024
    ds_read_b32 v24, v109 offset:2048
    s_lshl_b32 s36, s31, 5
    s_add_u32 s36, s36, s29
    s_lshl_b32 s36, s36, 10
    s_add_u32 s36, s36, 10682368
    s_waitcnt lgkmcnt(0)
    v_add_f32 v48, v48, v16
    v_add_f32 v49, v49, v17
    v_add_f32 v50, v50, v18
    v_add_f32 v51, v51, v19
    v_add_f32 v52, v52, v20
    v_add_f32 v53, v53, v21
    v_add_f32 v54, v54, v22
    v_add_f32 v55, v55, v23
    v_add_f32 v56, v56, v24
    v_mov_b32 v105, v56
    v_mov_b32 v106, v56
    s_nop 1
    v_permlane32_swap_b32 v105, v106
    s_nop 1
    v_rcp_f32 v105, v105
    s_nop 0
    v_mul_f32 v48, v48, v105
    v_mul_f32 v49, v49, v105
    v_mul_f32 v50, v50, v105
    v_mul_f32 v51, v51, v105
    v_mul_f32 v52, v52, v105
    v_mul_f32 v53, v53, v105
    v_mul_f32 v54, v54, v105
    v_mul_f32 v55, v55, v105
    v_cvt_pk_bf16_f32 v108, v48, v49
    v_cvt_pk_bf16_f32 v109, v50, v51
    v_cvt_pk_bf16_f32 v110, v52, v53
    v_cvt_pk_bf16_f32 v111, v54, v55
    buffer_store_dwordx4 v[108:111], v104, s[20:23], s36 offen sc1
    s_cmp_ge_u32 s3, 4
    s_cbranch_scc1 k4_B3
    s_lshl_b32 s28, s18, 2
    s_and_b32 s29, s19, 3
    s_add_u32 s28, s28, s29
    s_lshr_b32 s29, s19, 2
    v_lshrrev_b32 v4, 3, v1
    v_and_b32 v5, 7, v1
    s_lshl_b32 s33, s3, 4
    v_add_u32 v6, s33, v4
    v_mul_u32_u24 v7, 272, v6
    v_lshl_add_u32 v7, v5, 5, v7
    s_lshl_b32 s33, s28, 6
    v_add_u32 v6, s33, v6
    v_lshlrev_b32 v6, 11, v6
    v_lshl_add_u32 v6, v5, 4, v6
    s_lshl_b32 s35, s29, 7
    s_mov_b32 s24, s52
    s_and_b32 s25, s53, 0xffff
    s_mov_b32 s26, 4194304
    s_mov_b32 s27, 0x20000
    v_mov_b32 v3, 163784
k4_cw4:
    ds_read_b32 v4, v3
    s_waitcnt lgkmcnt(0)
    v_readfirstlane_b32 s48, v4
    s_nop 0
    s_cmp_ge_u32 s48, 4
    s_cbranch_scc1 k4_cw4_ok
    s_sleep 1
    s_branch k4_cw4
k4_cw4_ok:
    ds_read_b128 v[8:11], v7 offset:2176
    ds_read_b128 v[12:15], v7 offset:2192
    ds_read_b128 v[16:19], v7 offset:19584
    ds_read_b128 v[20:23], v7 offset:19600
    ds_read_b128 v[24:27], v7 offset:36992
    ds_read_b128 v[28:31], v7 offset:37008
    ds_read_b128 v[32:35], v7 offset:54400
    ds_read_b128 v[36:39], v7 offset:54416
    s_waitcnt lgkmcnt(4)
    v_add_f32 v8, v8, v16
    v_add_f32 v9, v9, v17
    v_add_f32 v10, v10, v18
    v_add_f32 v11, v11, v19
    v_add_f32 v12, v12, v20
    v_add_f32 v13, v13, v21
    v_add_f32 v14, v14, v22
    v_add_f32 v15, v15, v23
    s_waitcnt lgkmcnt(0)
    v_add_f32 v24, v24, v32
    v_add_f32 v25, v25, v33
    v_add_f32 v26, v26, v34
    v_add_f32 v27, v27, v35
    v_add_f32 v28, v28, v36
    v_add_f32 v29, v29, v37
    v_add_f32 v30, v30, v38
    v_add_f32 v31, v31, v39
    v_add_f32 v8, v8, v24
    v_add_f32 v9, v9, v25
    v_add_f32 v10, v10, v26
    v_add_f32 v11, v11, v27
    v_add_f32 v12, v12, v28
    v_add_f32 v13, v13, v29
    v_add_f32 v14, v14, v30
    v_add_f32 v15, v15, v31
    v_cvt_pk_bf16_f32 v80, v8, v9
    v_cvt_pk_bf16_f32 v81, v10, v11
    v_cvt_pk_bf16_f32 v82, v12, v13
    v_cvt_pk_bf16_f32 v83, v14, v15
    s_add_u32 s36, s35, 16384
    buffer_store_dwordx4 v[80:83], v6, s[24:27], s36 offen sc1
    s_endpgm
k4_seg1:
    v_mov_b32 v104, 163788
k4_cw5:
    ds_read_b32 v105, v104
    s_waitcnt lgkmcnt(0)
    v_readfirstlane_b32 s48, v105
    s_nop 0
    s_cmp_ge_u32 s48, 4
    s_cbranch_scc1 k4_cw5_ok
    s_sleep 1
    s_branch k4_cw5
k4_cw5_ok:
    s_mov_b32 s43, 2
    s_branch k4_lean
k4_seg2:
    v_mov_b32 v104, 163792
k4_cw6:
    ds_read_b32 v105, v104
    s_waitcnt lgkmcnt(0)
    v_readfirstlane_b32 s48, v105
    s_nop 0
    s_cmp_ge_u32 s48, 4
    s_cbranch_scc1 k4_cw6_ok
    s_sleep 1
    s_branch k4_cw6
k4_cw6_ok:
    s_mov_b32 s43, 3
    s_branch k4_lean
k4_seg3:
    v_mov_b32 v104, 163796
k4_cw7:
    ds_read_b32 v105, v104
    s_waitcnt lgkmcnt(0)
    v_readfirstlane_b32 s48, v105
    s_nop 0
    s_cmp_ge_u32 s48, 1
    s_cbranch_scc1 k4_cw7_ok
    s_sleep 1
    s_branch k4_cw7
k4_cw7_ok:
    s_cmp_lt_u32 s3, 4
    s_cbranch_scc0 k4_seg3n
    s_setprio 0
k4_seg3n:
    s_mov_b32 s43, 2
    s_branch k4_lean
k4_fallback:
    s_mov_b32 s57, 1
    v_mov_b32 v104, 163792
k4_cw8:
    ds_read_b32 v105, v104
    s_waitcnt lgkmcnt(0)
    v_readfirstlane_b32 s48, v105
    s_nop 0
    s_cmp_ge_u32 s48, 4
    s_cbranch_scc1 k4_cw8_ok
    s_sleep 1
    s_branch k4_cw8
k4_cw8_ok:
    v_mov_b32 v105, 0xff800000
    v_mov_b32 v106, 0xff800000
    v_and_b32 v107, 31, v1
    v_lshrrev_b32 v108, 5, v1
    v_lshlrev_b32 v108, 10, v108
    v_lshl_add_u32 v107, v107, 4, v108
    s_mov_b32 s42, 64
k4_fb_max:
    ds_read_b128 v[80:83], v107
    v_add_u32 v107, 2048, v107
    s_waitcnt lgkmcnt(0)
    v_mfma_f32_32x32x16_bf16 v[16:31], v[80:83], v[8:11], 0
    v_mfma_f32_32x32x16_bf16 v[112:127], v[80:83], v[12:15], 0
    s_nop 15
    v_max3_f32 v105, v16, v17, v105
    v_max3_f32 v105, v18, v19, v105
    v_max3_f32 v105, v20, v21, v105
    v_max3_f32 v105, v22, v23, v105
    v_max3_f32 v105, v24, v25, v105
    v_max3_f32 v105, v26, v27, v105
    v_max3_f32 v105, v28, v29, v105
    v_max3_f32 v105, v30, v31, v105
    v_max3_f32 v106, v112, v113, v106
    v_max3_f32 v106, v114, v115, v106
    v_max3_f32 v106, v116, v117, v106
    v_max3_f32 v106, v118, v119, v106
    v_max3_f32 v106, v120, v121, v106
    v_max3_f32 v106, v122, v123, v106
    v_max3_f32 v106, v124, v125, v106
    v_max3_f32 v106, v126, v127, v106
    s_sub_u32 s42, s42, 1
    s_cmp_lg_u32 s42, 0
    s_cbranch_scc1 k4_fb_max
    v_mov_b32 v107, v105
    v_mov_b32 v108, v106
    s_nop 1
    v_permlane32_swap_b32 v105, v107
    v_permlane32_swap_b32 v106, v108
    s_nop 1
    v_max_f32 v105, v105, v107
    v_max_f32 v106, v106, v108
    v_sub_f32 v112, 0, v105
    v_sub_f32 v113, 0, v105
    v_sub_f32 v114, 0, v105
    v_sub_f32 v115, 0, v105
    v_sub_f32 v116, 0, v105
    v_sub_f32 v117, 0, v105
    v_sub_f32 v118, 0, v105
    v_sub_f32 v119, 0, v105
    v_sub_f32 v120, 0, v105
    v_sub_f32 v121, 0, v105
    v_sub_f32 v122, 0, v105
    v_sub_f32 v123, 0, v105
    v_sub_f32 v124, 0, v105
    v_sub_f32 v125, 0, v105
    v_sub_f32 v126, 0, v105
    v_sub_f32 v127, 0, v105
    v_sub_f32 v128, 0, v106
    v_sub_f32 v129, 0, v106
    v_sub_f32 v130, 0, v106
    v_sub_f32 v131, 0, v106
    v_sub_f32 v132, 0, v106
    v_sub_f32 v133, 0, v106
    v_sub_f32 v134, 0, v106
    v_sub_f32 v135, 0, v106
    v_sub_f32 v136, 0, v106
    v_sub_f32 v137, 0, v106
    v_sub_f32 v138, 0, v106
    v_sub_f32 v139, 0, v106
    v_sub_f32 v140, 0, v106
    v_sub_f32 v141, 0, v106
    v_sub_f32 v142, 0, v106
    v_sub_f32 v143, 0, v106
    s_nop 1
    ds_read_b128 v[80:83], v2
    s_mov_b64 exec, s[62:63]
    ds_read_b128 v[84:87], v2 offset:512
    ds_read_b128 v[88:91], v2 offset:768
    s_mov_b64 exec, -1
    s_waitcnt lgkmcnt(2)
    v_mfma_f32_32x32x16_bf16 v[16:31], v[80:83], v[8:11], v[112:127]
    s_mov_b32 s42, 0
    s_waitcnt lgkmcnt(0)
    s_nop 11
k4_loop_fb:
    v_exp_f32 v16, v16
    v_exp_f32 v17, v17
    v_smfmac_f32_32x32x32_bf16 v[64:79], v[100:103], v[40:47], v4
    ds_read_b128 v[92:95], v2 offset:2048
    v_exp_f32 v18, v18
    v_exp_f32 v19, v19
    v_exp_f32 v20, v20
    v_mfma_f32_32x32x16_bf16 v[32:47], v[80:83], v[12:15], v[128:143]
    v_exp_f32 v21, v21
    v_exp_f32 v22, v22
    s_mov_b64 exec, s[62:63]
    ds_read_b128 v[96:99], v2 offset:2560
    ds_read_b128 v[100:103], v2 offset:2816
    s_mov_b64 exec, -1
    v_exp_f32 v23, v23
    v_exp_f32 v24, v24
    v_exp_f32 v25, v25
    v_exp_f32 v26, v26
    v_exp_f32 v27, v27
    v_smfmac_f32_32x32x32_bf16 v[48:63], v[84:87], v[16:23], v4
    v_exp_f32 v28, v28
    v_exp_f32 v29, v29
    v_exp_f32 v30, v30
    v_exp_f32 v31, v31
    v_exp_f32 v32, v32
    v_exp_f32 v33, v33
    v_smfmac_f32_32x32x32_bf16 v[48:63], v[88:91], v[24:31], v4
    v_exp_f32 v34, v34
    v_exp_f32 v35, v35
    v_exp_f32 v36, v36
    s_waitcnt lgkmcnt(0)
    v_mfma_f32_32x32x16_bf16 v[16:31], v[92:95], v[8:11], v[112:127]
    v_exp_f32_e64 v37, v37
    v_exp_f32 v38, v38
    v_exp_f32 v39, v39
    v_exp_f32 v40, v40
    v_exp_f32 v41, v41
    v_exp_f32 v42, v42
    v_exp_f32 v43, v43
    v_smfmac_f32_32x32x32_bf16 v[64:79], v[84:87], v[32:39], v4
    v_exp_f32 v44, v44
    v_exp_f32 v45, v45
    v_exp_f32 v46, v46
    v_exp_f32 v47, v47
    v_exp_f32 v16, v16
    v_exp_f32 v17, v17
    v_smfmac_f32_32x32x32_bf16 v[64:79], v[88:91], v[40:47], v4
    ds_read_b128 v[80:83], v2 offset:4096
    v_exp_f32 v18, v18
    v_exp_f32 v19, v19
    v_exp_f32 v20, v20
    v_mfma_f32_32x32x16_bf16 v[32:47], v[92:95], v[12:15], v[128:143]
    v_exp_f32 v21, v21
    v_exp_f32 v22, v22
    s_mov_b64 exec, s[62:63]
    ds_read_b128 v[84:87], v2 offset:4608
    ds_read_b128 v[88:91], v2 offset:4864
    s_mov_b64 exec, -1
    v_exp_f32 v23, v23
    v_exp_f32 v24, v24
    v_exp_f32 v25, v25
    v_exp_f32 v26, v26
    v_exp_f32 v27, v27
    v_smfmac_f32_32x32x32_bf16 v[48:63], v[96:99], v[16:23], v4
    v_exp_f32 v28, v28
    v_exp_f32 v29, v29
    v_exp_f32 v30, v30
    v_exp_f32 v31, v31
    v_exp_f32 v32, v32
    v_exp_f32 v33, v33
    v_smfmac_f32_32x32x32_bf16 v[48:63], v[100:103], v[24:31], v4
    v_exp_f32 v34, v34
    v_exp_f32 v35, v35
    v_exp_f32 v36, v36
    s_waitcnt lgkmcnt(0)
    v_mfma_f32_32x32x16_bf16 v[16:31], v[80:83], v[8:11], v[112:127]
    v_exp_f32_e64 v37, v37
    v_exp_f32 v38, v38
    v_exp_f32 v39, v39
    v_exp_f32 v40, v40
    v_exp_f32 v41, v41
    v_exp_f32 v42, v42
    v_exp_f32 v43, v43
    v_smfmac_f32_32x32x32_bf16 v[64:79], v[96:99], v[32:39], v4
    v_exp_f32 v44, v44
    v_exp_f32 v45, v45
    v_exp_f32 v46, v46
    v_exp_f32 v47, v47
    v_add_u32 v2, 4096, v2
    s_add_u32 s42, s42, 1
    s_cmp_lt_u32 s42, 16
    s_cbranch_scc1 k4_loop_fb
    s_branch k4_tail
k4_B3:
    s_sub_u32 s28, s3, 4
    s_lshr_b32 s29, s19, 3
    s_lshl_b32 s29, s29, 3
    s_add_u32 s29, s29, s18
    s_and_b32 s30, s19, 7
    v_and_b32 v3, 15, v1
    v_lshrrev_b32 v4, 4, v1
    v_cvt_f32_u32 v5, v3
    v_lshlrev_b32 v6, 2, v4
    v_cvt_f32_u32 v6, v6
    s_mov_b32 s24, s52
    s_and_b32 s25, s53, 0xffff
    s_mov_b32 s26, 4194304
    s_mov_b32 s27, 0x20000
    v_mul_f32 v128, 0x3d800000, v5
    v_mov_b32 v129, v6
    v_add_f32 v130, 1.0, v6
    v_add_f32 v131, 2.0, v6
    v_add_f32 v132, 3.0, v6
    v_mul_f32 v129, v129, v128
    v_mul_f32 v130, v130, v128
    v_mul_f32 v131, v131, v128
    v_mul_f32 v132, v132, v128
    v_cos_f32 v133, v129
    v_sin_f32 v137, v129
    v_cos_f32 v134, v130
    v_sin_f32 v138, v130
    v_cos_f32 v135, v131
    v_sin_f32 v139, v131
    v_cos_f32 v136, v132
    v_sin_f32 v140, v132
    s_mov_b32 s40, 0x35000000
    v_mul_f32 v133, s40, v133
    v_mul_f32 v134, s40, v134
    v_mul_f32 v135, s40, v135
    v_mul_f32 v136, s40, v136
    v_mul_f32 v137, s40, v137
    v_mul_f32 v138, s40, v138
    v_mul_f32 v139, s40, v139
    v_mul_f32 v140, s40, v140
    v_cvt_pk_bf16_f32 v8, v133, -v137
    v_cvt_pk_bf16_f32 v12, v137, v133
    v_cvt_pk_bf16_f32 v9, v134, -v138
    v_cvt_pk_bf16_f32 v13, v138, v134
    v_cvt_pk_bf16_f32 v10, v135, -v139
    v_cvt_pk_bf16_f32 v14, v139, v135
    v_cvt_pk_bf16_f32 v11, v136, -v140
    v_cvt_pk_bf16_f32 v15, v140, v136
    v_mul_f32 v128, 0x3b000000, v5
    v_mov_b32 v129, v6
    v_add_f32 v130, 0x3f800000, v6
    v_add_f32 v131, 0x40000000, v6
    v_add_f32 v132, 0x40400000, v6
    v_add_f32 v133, 0x41800000, v6
    v_add_f32 v134, 0x41880000, v6
    v_add_f32 v135, 0x41900000, v6
    v_add_f32 v136, 0x41980000, v6
    v_mul_f32 v129, v129, v128
    v_mul_f32 v130, v130, v128
    v_mul_f32 v131, v131, v128
    v_mul_f32 v132, v132, v128
    v_mul_f32 v133, v133, v128
    v_mul_f32 v134, v134, v128
    v_mul_f32 v135, v135, v128
    v_mul_f32 v136, v136, v128
    v_cos_f32 v16, v129
    v_sin_f32 v24, -v129
    v_cos_f32 v17, v130
    v_sin_f32 v25, -v130
    v_cos_f32 v18, v131
    v_sin_f32 v26, -v131
    v_cos_f32 v19, v132
    v_sin_f32 v27, -v132
    v_cos_f32 v20, v133
    v_sin_f32 v28, -v133
    v_cos_f32 v21, v134
    v_sin_f32 v29, -v134
    v_cos_f32 v22, v135
    v_sin_f32 v30, -v135
    v_cos_f32 v23, v136
    v_sin_f32 v31, -v136
    v_mov_b32 v129, v6
    v_add_f32 v130, 0x3f800000, v6
    v_add_f32 v131, 0x40000000, v6
    v_add_f32 v132, 0x40400000, v6
    v_add_f32 v133, 0x41800000, v6
    v_add_f32 v134, 0x41880000, v6
    v_add_f32 v135, 0x41900000, v6
    v_add_f32 v136, 0x41980000, v6
    v_mul_f32 v137, 0x3d000000, v5
    v_add_f32 v138, 0.5, v137
    v_mul_f32 v139, v129, v137
    v_mul_f32 v140, v130, v137
    v_mul_f32 v141, v131, v137
    v_mul_f32 v142, v132, v137
    v_mul_f32 v143, v133, v137
    v_mul_f32 v144, v134, v137
    v_mul_f32 v145, v135, v137
    v_mul_f32 v146, v136, v137
    v_cos_f32 v147, v139
    v_sin_f32 v139, v139
    v_cos_f32 v148, v140
    v_sin_f32 v140, v140
    v_cos_f32 v149, v141
    v_sin_f32 v141, v141
    v_cos_f32 v150, v142
    v_sin_f32 v142, v142
    v_cos_f32 v151, v143
    v_sin_f32 v143, v143
    v_cos_f32 v152, v144
    v_sin_f32 v144, v144
    v_cos_f32 v153, v145
    v_sin_f32 v145, v145
    v_cos_f32 v154, v146
    v_sin_f32 v146, v146
    s_nop 0
    v_cvt_pk_bf16_f32 v32, v147, -v139
    v_cvt_pk_bf16_f32 v40, v139, v147
    v_cvt_pk_bf16_f32 v33, v148, -v140
    v_cvt_pk_bf16_f32 v41, v140, v148
    v_cvt_pk_bf16_f32 v34, v149, -v141
    v_cvt_pk_bf16_f32 v42, v141, v149
    v_cvt_pk_bf16_f32 v35, v150, -v142
    v_cvt_pk_bf16_f32 v43, v142, v150
    v_cvt_pk_bf16_f32 v36, v151, -v143
    v_cvt_pk_bf16_f32 v44, v143, v151
    v_cvt_pk_bf16_f32 v37, v152, -v144
    v_cvt_pk_bf16_f32 v45, v144, v152
    v_cvt_pk_bf16_f32 v38, v153, -v145
    v_cvt_pk_bf16_f32 v46, v145, v153
    v_cvt_pk_bf16_f32 v39, v154, -v146
    v_cvt_pk_bf16_f32 v47, v146, v154
    v_mul_f32 v139, v129, v138
    v_mul_f32 v140, v130, v138
    v_mul_f32 v141, v131, v138
    v_mul_f32 v142, v132, v138
    v_mul_f32 v143, v133, v138
    v_mul_f32 v144, v134, v138
    v_mul_f32 v145, v135, v138
    v_mul_f32 v146, v136, v138
    v_cos_f32 v147, v139
    v_sin_f32 v139, v139
    v_cos_f32 v148, v140
    v_sin_f32 v140, v140
    v_cos_f32 v149, v141
    v_sin_f32 v141, v141
    v_cos_f32 v150, v142
    v_sin_f32 v142, v142
    v_cos_f32 v151, v143
    v_sin_f32 v143, v143
    v_cos_f32 v152, v144
    v_sin_f32 v144, v144
    v_cos_f32 v153, v145
    v_sin_f32 v145, v145
    v_cos_f32 v154, v146
    v_sin_f32 v146, v146
    s_nop 0
    v_cvt_pk_bf16_f32 v48, v147, -v139
    v_cvt_pk_bf16_f32 v56, v139, v147
    v_cvt_pk_bf16_f32 v49, v148, -v140
    v_cvt_pk_bf16_f32 v57, v140, v148
    v_cvt_pk_bf16_f32 v50, v149, -v141
    v_cvt_pk_bf16_f32 v58, v141, v149
    v_cvt_pk_bf16_f32 v51, v150, -v142
    v_cvt_pk_bf16_f32 v59, v142, v150
    v_cvt_pk_bf16_f32 v52, v151, -v143
    v_cvt_pk_bf16_f32 v60, v143, v151
    v_cvt_pk_bf16_f32 v53, v152, -v144
    v_cvt_pk_bf16_f32 v61, v144, v152
    v_cvt_pk_bf16_f32 v54, v153, -v145
    v_cvt_pk_bf16_f32 v62, v145, v153
    v_cvt_pk_bf16_f32 v55, v154, -v146
    v_cvt_pk_bf16_f32 v63, v146, v154
    v_lshl_add_u32 v128, v4, 7, v3
    v_sub_u32 v129, 512, v128
    v_cmp_gt_u32 vcc, 32, v1
    v_mov_b32 v130, -1.0
    v_mov_b32 v131, -512
    v_cndmask_b32 v128, v129, v128, vcc
    v_cndmask_b32 v7, v130, 1.0, vcc
    v_mov_b32 v132, 512
    v_cndmask_b32 v131, v131, v132, vcc
    s_lshl_b32 s33, s28, 3
    s_add_u32 s33, s33, 139264
    v_lshl_add_u32 v128, v128, 5, s33
    v_mov_b32 v133, s33
    v_cmp_eq_u32 vcc, 32, v1
    v_add_u32 v135, v128, v131
    s_nop 0
    v_cndmask_b32 v134, v128, v133, vcc
    s_mov_b64 s[36:37], vcc
    ds_read_b64 v[64:65], v134
    ds_read_b64 v[72:73], v135
    v_add_u32 v135, v135, v131
    ds_read_b64 v[66:67], v135
    v_add_u32 v135, v135, v131
    ds_read_b64 v[74:75], v135
    v_add_u32 v135, v135, v131
    ds_read_b64 v[68:69], v135
    v_add_u32 v135, v135, v131
    ds_read_b64 v[76:77], v135
    v_add_u32 v135, v135, v131
    ds_read_b64 v[70:71], v135
    v_add_u32 v135, v135, v131
    ds_read_b64 v[78:79], v135
    v_cmp_eq_u32 vcc, 0, v1
    s_nop 1
    s_or_b64 s[38:39], vcc, s[36:37]
    v_cndmask_b32 v136, v7, 0, s[38:39]
    s_waitcnt lgkmcnt(0)
    v_lshlrev_b32 v138, 16, v64
    v_and_b32 v139, 0xffff0000, v64
    v_lshlrev_b32 v140, 16, v65
    v_and_b32 v141, 0xffff0000, v65
    v_cndmask_b32 v138, v138, v139, s[36:37]
    v_cndmask_b32 v140, v140, v141, s[36:37]
    v_fma_f32 v142, -v136, v141, v138
    v_fma_f32 v143, v136, v139, v140
    v_cvt_pk_bf16_f32 v80, v142, v143
    v_lshlrev_b32 v138, 16, v66
    v_and_b32 v139, 0xffff0000, v66
    v_lshlrev_b32 v140, 16, v67
    v_and_b32 v141, 0xffff0000, v67
    v_fma_f32 v142, -v7, v141, v138
    v_fma_f32 v143, v7, v139, v140
    v_cvt_pk_bf16_f32 v81, v142, v143
    v_lshlrev_b32 v138, 16, v68
    v_and_b32 v139, 0xffff0000, v68
    v_lshlrev_b32 v140, 16, v69
    v_and_b32 v141, 0xffff0000, v69
    v_fma_f32 v142, -v7, v141, v138
    v_fma_f32 v143, v7, v139, v140
    v_cvt_pk_bf16_f32 v82, v142, v143
    v_lshlrev_b32 v138, 16, v70
    v_and_b32 v139, 0xffff0000, v70
    v_lshlrev_b32 v140, 16, v71
    v_and_b32 v141, 0xffff0000, v71
    v_fma_f32 v142, -v7, v141, v138
    v_fma_f32 v143, v7, v139, v140
    v_cvt_pk_bf16_f32 v83, v142, v143
    v_lshlrev_b32 v138, 16, v72
    v_and_b32 v139, 0xffff0000, v72
    v_lshlrev_b32 v140, 16, v73
    v_and_b32 v141, 0xffff0000, v73
    v_fma_f32 v142, -v7, v141, v138
    v_fma_f32 v143, v7, v139, v140
    v_cvt_pk_bf16_f32 v84, v142, v143
    v_lshlrev_b32 v138, 16, v74
    v_and_b32 v139, 0xffff0000, v74
    v_lshlrev_b32 v140, 16, v75
    v_and_b32 v141, 0xffff0000, v75
    v_fma_f32 v142, -v7, v141, v138
    v_fma_f32 v143, v7, v139, v140
    v_cvt_pk_bf16_f32 v85, v142, v143
    v_lshlrev_b32 v138, 16, v76
    v_and_b32 v139, 0xffff0000, v76
    v_lshlrev_b32 v140, 16, v77
    v_and_b32 v141, 0xffff0000, v77
    v_fma_f32 v142, -v7, v141, v138
    v_fma_f32 v143, v7, v139, v140
    v_cvt_pk_bf16_f32 v86, v142, v143
    v_lshlrev_b32 v138, 16, v78
    v_and_b32 v139, 0xffff0000, v78
    v_lshlrev_b32 v140, 16, v79
    v_and_b32 v141, 0xffff0000, v79
    v_fma_f32 v142, -v7, v141, v138
    v_fma_f32 v143, v7, v139, v140
    v_cvt_pk_bf16_f32 v87, v142, v143
    s_nop 1
    v_mfma_f32_16x16x32_bf16 v[88:91], v[80:83], v[8:11], 0
    v_mfma_f32_16x16x32_bf16 v[92:95], v[80:83], v[12:15], 0
    v_mfma_f32_16x16x32_bf16 v[96:99], v[84:87], v[8:11], 0
    v_mfma_f32_16x16x32_bf16 v[100:103], v[84:87], v[12:15], 0
    s_nop 7
    v_pk_mul_f32 v[128:129], v[88:89], v[16:17]
    v_pk_mul_f32 v[132:133], v[92:93], v[16:17]
    v_pk_mul_f32 v[130:131], v[90:91], v[18:19]
    v_pk_mul_f32 v[134:135], v[94:95], v[18:19]
    v_pk_fma_f32 v[128:129], v[92:93], v[24:25], v[128:129]
    v_pk_fma_f32 v[132:133], v[88:89], v[24:25], v[132:133] neg_lo:[1,0,0] neg_hi:[1,0,0]
    v_pk_fma_f32 v[130:131], v[94:95], v[26:27], v[130:131]
    v_pk_fma_f32 v[134:135], v[90:91], v[26:27], v[134:135] neg_lo:[1,0,0] neg_hi:[1,0,0]
    v_cvt_pk_bf16_f32 v80, v128, v132
    v_cvt_pk_bf16_f32 v81, v129, v133
    v_cvt_pk_bf16_f32 v82, v130, v134
    v_cvt_pk_bf16_f32 v83, v131, v135
    v_pk_mul_f32 v[128:129], v[96:97], v[20:21]
    v_pk_mul_f32 v[132:133], v[100:101], v[20:21]
    v_pk_mul_f32 v[130:131], v[98:99], v[22:23]
    v_pk_mul_f32 v[134:135], v[102:103], v[22:23]
    v_pk_fma_f32 v[128:129], v[100:101], v[28:29], v[128:129]
    v_pk_fma_f32 v[132:133], v[96:97], v[28:29], v[132:133] neg_lo:[1,0,0] neg_hi:[1,0,0]
    v_pk_fma_f32 v[130:131], v[102:103], v[30:31], v[130:131]
    v_pk_fma_f32 v[134:135], v[98:99], v[30:31], v[134:135] neg_lo:[1,0,0] neg_hi:[1,0,0]
    v_cvt_pk_bf16_f32 v84, v128, v132
    v_cvt_pk_bf16_f32 v85, v129, v133
    v_cvt_pk_bf16_f32 v86, v130, v134
    v_cvt_pk_bf16_f32 v87, v131, v135
    s_nop 1
    v_mfma_f32_16x16x32_bf16 v[112:115], v[80:83], v[32:35], 0
    v_mfma_f32_16x16x32_bf16 v[116:119], v[80:83], v[40:43], 0
    v_mfma_f32_16x16x32_bf16 v[120:123], v[80:83], v[48:51], 0
    v_mfma_f32_16x16x32_bf16 v[124:127], v[80:83], v[56:59], 0
    v_mfma_f32_16x16x32_bf16 v[112:115], v[84:87], v[36:39], v[112:115]
    v_mfma_f32_16x16x32_bf16 v[116:119], v[84:87], v[44:47], v[116:119]
    v_mfma_f32_16x16x32_bf16 v[120:123], v[84:87], v[52:55], v[120:123]
    v_mfma_f32_16x16x32_bf16 v[124:127], v[84:87], v[60:63], v[124:127]
    v_lshlrev_b32 v128, 5, v3
    v_lshl_add_u32 v128, v4, 3, v128
    s_lshl_b32 s33, s30, 3
    s_lshl_b32 s34, s28, 1
    s_add_u32 s33, s33, s34
    s_lshl_b32 s33, s33, 5
    s_add_u32 s33, s33, s29
    s_lshl_b32 s33, s33, 11
    s_add_u32 s33, s33, 1024
    s_nop 3
    v_cvt_pk_bf16_f32 v130, v112, v113
    v_cvt_pk_bf16_f32 v131, v114, v115
    s_add_u32 s34, s33, 0
    buffer_store_dwordx2 v[130:131], v128, s[24:27], s34 offen sc1
    v_cvt_pk_bf16_f32 v132, v120, v121
    v_cvt_pk_bf16_f32 v133, v122, v123
    s_add_u32 s34, s33, 512
    buffer_store_dwordx2 v[132:133], v128, s[24:27], s34 offen sc1
    v_cvt_pk_bf16_f32 v134, v116, v117
    v_cvt_pk_bf16_f32 v135, v118, v119
    s_add_u32 s34, s33, 65536
    buffer_store_dwordx2 v[134:135], v128, s[24:27], s34 offen sc1
    v_cvt_pk_bf16_f32 v136, v124, v125
    v_cvt_pk_bf16_f32 v137, v126, v127
    s_add_u32 s34, s33, 66048
    buffer_store_dwordx2 v[136:137], v128, s[24:27], s34 offen sc1
    s_endpgm
k4_C:
    s_sub_u32 s3, s3, 8
    s_setprio 3
    s_lshl_b32 s34, s3, 10
    s_mul_i32 s35, s29, 131072
    s_add_u32 s35, s35, s34
    s_add_u32 s35, s35, 2097152
    s_add_u32 m0, s34, 0
    s_add_u32 s36, s35, 0
    buffer_load_dwordx4 v104, s[20:23], s36 offen lds
    s_add_u32 m0, s34, 65536
    s_add_u32 s36, s35, 65536
    buffer_load_dwordx4 v104, s[20:23], s36 offen lds
    s_add_u32 m0, s34, 4096
    s_add_u32 s36, s35, 4096
    buffer_load_dwordx4 v104, s[20:23], s36 offen lds
    s_add_u32 m0, s34, 69632
    s_add_u32 s36, s35, 69632
    buffer_load_dwordx4 v104, s[20:23], s36 offen lds
    s_add_u32 m0, s34, 8192
    s_add_u32 s36, s35, 8192
    buffer_load_dwordx4 v104, s[20:23], s36 offen lds
    s_add_u32 m0, s34, 73728
    s_add_u32 s36, s35, 73728
    buffer_load_dwordx4 v104, s[20:23], s36 offen lds
    s_cmp_eq_u32 s3, 0
    s_cbranch_scc0 k4_noinit
    v_mov_b32 v107, 163776
    v_mov_b32 v108, 0
    v_mov_b32 v109, 0
    v_mov_b32 v110, 0
    v_mov_b32 v111, 0
    ds_write_b128 v107, v[108:111]
    ds_write_b128 v107, v[108:111] offset:16
    ds_write_b128 v107, v[108:111] offset:32
    ds_write_b128 v107, v[108:111] offset:48
    s_or_b32 s57, s2, s3
    s_cmp_eq_u32 s57, 0
    s_cbranch_scc0 k4_nononce
    s_memrealtime s[56:57]
    s_waitcnt lgkmcnt(0)
    s_or_b32 s56, s56, 1
    v_mov_b32 v2, 0
    v_mov_b32 v3, s56
    s_mov_b64 exec, 1
    global_store_dword v2, v3, s[54:55] sc1
    s_mov_b64 exec, -1
k4_nononce:
    s_waitcnt lgkmcnt(0)
k4_noinit:
    s_barrier
    s_add_u32 m0, s34, 12288
    s_add_u32 s36, s35, 12288
    buffer_load_dwordx4 v104, s[20:23], s36 offen lds
    s_add_u32 m0, s34, 77824
    s_add_u32 s36, s35, 77824
    buffer_load_dwordx4 v104, s[20:23], s36 offen lds
    s_add_u32 m0, s34, 16384
    s_add_u32 s36, s35, 16384
    buffer_load_dwordx4 v104, s[20:23], s36 offen lds
    s_add_u32 m0, s34, 81920
    s_add_u32 s36, s35, 81920
    buffer_load_dwordx4 v104, s[20:23], s36 offen lds
    s_add_u32 m0, s34, 20480
    s_add_u32 s36, s35, 20480
    buffer_load_dwordx4 v104, s[20:23], s36 offen lds
    s_add_u32 m0, s34, 86016
    s_add_u32 s36, s35, 86016
    buffer_load_dwordx4 v104, s[20:23], s36 offen lds
    s_add_u32 m0, s34, 24576
    s_add_u32 s36, s35, 24576
    buffer_load_dwordx4 v104, s[20:23], s36 offen lds
    s_add_u32 m0, s34, 90112
    s_add_u32 s36, s35, 90112
    buffer_load_dwordx4 v104, s[20:23], s36 offen lds
    s_add_u32 m0, s34, 28672
    s_add_u32 s36, s35, 28672
    buffer_load_dwordx4 v104, s[20:23], s36 offen lds
    s_add_u32 m0, s34, 94208
    s_add_u32 s36, s35, 94208
    buffer_load_dwordx4 v104, s[20:23], s36 offen lds
    s_waitcnt vmcnt(10)
    v_mov_b32 v105, 163780
    v_mov_b32 v106, 1
    s_mov_b64 exec, 1
    ds_add_u32 v105, v106
    s_mov_b64 exec, -1
    s_add_u32 m0, s34, 32768
    s_add_u32 s36, s35, 32768
    buffer_load_dwordx4 v104, s[20:23], s36 offen lds
    s_add_u32 m0, s34, 98304
    s_add_u32 s36, s35, 98304
    buffer_load_dwordx4 v104, s[20:23], s36 offen lds
    s_add_u32 m0, s34, 36864
    s_add_u32 s36, s35, 36864
    buffer_load_dwordx4 v104, s[20:23], s36 offen lds
    s_add_u32 m0, s34, 102400
    s_add_u32 s36, s35, 102400
    buffer_load_dwordx4 v104, s[20:23], s36 offen lds
    s_add_u32 m0, s34, 40960
    s_add_u32 s36, s35, 40960
    buffer_load_dwordx4 v104, s[20:23], s36 offen lds
    s_add_u32 m0, s34, 106496
    s_add_u32 s36, s35, 106496
    buffer_load_dwordx4 v104, s[20:23], s36 offen lds
    s_add_u32 m0, s34, 45056
    s_add_u32 s36, s35, 45056
    buffer_load_dwordx4 v104, s[20:23], s36 offen lds
    s_add_u32 m0, s34, 110592
    s_add_u32 s36, s35, 110592
    buffer_load_dwordx4 v104, s[20:23], s36 offen lds
    s_add_u32 m0, s34, 49152
    s_add_u32 s36, s35, 49152
    buffer_load_dwordx4 v104, s[20:23], s36 offen lds
    s_add_u32 m0, s34, 114688
    s_add_u32 s36, s35, 114688
    buffer_load_dwordx4 v104, s[20:23], s36 offen lds
    s_add_u32 m0, s34, 53248
    s_add_u32 s36, s35, 53248
    buffer_load_dwordx4 v104, s[20:23], s36 offen lds
    s_add_u32 m0, s34, 118784
    s_add_u32 s36, s35, 118784
    buffer_load_dwordx4 v104, s[20:23], s36 offen lds
    s_add_u32 m0, s34, 57344
    s_add_u32 s36, s35, 57344
    buffer_load_dwordx4 v104, s[20:23], s36 offen lds
    s_add_u32 m0, s34, 122880
    s_add_u32 s36, s35, 122880
    buffer_load_dwordx4 v104, s[20:23], s36 offen lds
    s_add_u32 m0, s34, 61440
    s_add_u32 s36, s35, 61440
    buffer_load_dwordx4 v104, s[20:23], s36 offen lds
    s_add_u32 m0, s34, 126976
    s_add_u32 s36, s35, 126976
    buffer_load_dwordx4 v104, s[20:23], s36 offen lds
    s_waitcnt vmcnt(16)
    v_mov_b32 v105, 163788
    v_mov_b32 v106, 1
    s_mov_b64 exec, 1
    ds_add_u32 v105, v106
    s_mov_b64 exec, -1
    v_lshrrev_b32 v107, 4, v1
    s_lshl_b32 s32, s3, 3
    v_add_u32 v108, s32, v107
    v_and_b32 v109, 15, v108
    v_and_b32 v110, 15, v1
    v_xor_b32 v109, v109, v110
    v_lshlrev_b32 v109, 4, v109
    v_lshl_add_u32 v109, v108, 8, v109
    v_xor_b32 v110, 64, v109
    v_add_u32 v110, 1024, v110
    s_lshl_b32 s32, s28, 13
    s_add_u32 s32, s32, 6488064
    s_lshl_b32 s33, s3, 11
    s_add_u32 m0, s33, 131072
    s_nop 0
    buffer_load_dwordx4 v109, s[20:23], s32 offen lds
    s_add_u32 m0, s33, 132096
    s_nop 0
    buffer_load_dwordx4 v110, s[20:23], s32 offen lds
    s_lshl_b32 s36, s3, 13
    s_add_u32 s36, s36, 13303808
    buffer_load_dwordx4 v[8:11], v104, s[20:23], s36 offen offset:0
    buffer_load_dwordx4 v[12:15], v104, s[20:23], s36 offen offset:1024
    buffer_load_dwordx4 v[16:19], v104, s[20:23], s36 offen offset:2048
    buffer_load_dwordx4 v[20:23], v104, s[20:23], s36 offen offset:3072
    s_add_u32 s36, s36, 4096
    buffer_load_dwordx4 v[24:27], v104, s[20:23], s36 offen offset:0
    buffer_load_dwordx4 v[28:31], v104, s[20:23], s36 offen offset:1024
    buffer_load_dwordx4 v[32:35], v104, s[20:23], s36 offen offset:2048
    buffer_load_dwordx4 v[36:39], v104, s[20:23], s36 offen offset:3072
    s_lshl_b32 s36, s3, 12
    s_add_u32 s36, s36, 13344768
    buffer_load_dwordx4 v[72:75], v104, s[20:23], s36 offen offset:0
    buffer_load_dwordx4 v[76:79], v104, s[20:23], s36 offen offset:1024
    buffer_load_dwordx4 v[80:83], v104, s[20:23], s36 offen offset:2048
    buffer_load_dwordx4 v[84:87], v104, s[20:23], s36 offen offset:3072
    s_mov_b32 s36, 13336576
    buffer_load_dwordx4 v[40:43], v104, s[20:23], s36 offen offset:0
    buffer_load_dwordx4 v[44:47], v104, s[20:23], s36 offen offset:1024
    buffer_load_dwordx4 v[48:51], v104, s[20:23], s36 offen offset:2048
    buffer_load_dwordx4 v[52:55], v104, s[20:23], s36 offen offset:3072
    s_add_u32 s36, s36, 4096
    buffer_load_dwordx4 v[56:59], v104, s[20:23], s36 offen offset:0
    buffer_load_dwordx4 v[60:63], v104, s[20:23], s36 offen offset:1024
    buffer_load_dwordx4 v[64:67], v104, s[20:23], s36 offen offset:2048
    buffer_load_dwordx4 v[68:71], v104, s[20:23], s36 offen offset:3072
    s_lshl_b32 s36, s28, 13
    s_lshl_b32 s37, s3, 11
    s_add_u32 s36, s36, s37
    s_add_u32 s36, s36, 13631488
    buffer_load_dwordx4 v[88:91], v104, s[20:23], s36 offen
    buffer_load_dwordx4 v[92:95], v104, s[20:23], s36 offen offset:1024
    v_mov_b32 v108, -1
    v_mov_b32 v109, -1
    v_mov_b32 v110, -1
    v_mov_b32 v111, -1
    s_lshl_b32 s36, s31, 5
    s_add_u32 s36, s36, s29
    s_lshl_b32 s36, s36, 10
    s_add_u32 s36, s36, 10682368
    buffer_store_dwordx4 v[108:111], v104, s[20:23], s36 offen sc1
    s_add_u32 s36, s36, 32768
    buffer_store_dwordx4 v[108:111], v104, s[20:23], s36 offen sc1
    s_waitcnt vmcnt(26)
    v_mov_b32 v105, 163792
    v_mov_b32 v106, 1
    s_mov_b64 exec, 1
    ds_add_u32 v105, v106
    s_mov_b64 exec, -1
    s_call_b64 s[60:61], k2_b2
    s_waitcnt vmcnt(0)
    v_mov_b32 v111, 163776
    v_mov_b32 v110, 1
    s_waitcnt lgkmcnt(0)
    s_mov_b64 exec, 1
    ds_add_u32 v111, v110
    s_mov_b64 exec, -1
    s_add_u32 s47, s47, 4
k2_bbar_pub:
    ds_read_b32 v109, v111
    s_waitcnt lgkmcnt(0)
    v_readfirstlane_b32 s48, v109
    s_nop 0
    s_cmp_ge_u32 s48, s47
    s_cbranch_scc1 k2_bbar_pub_ok
    s_sleep 1
    s_branch k2_bbar_pub
k2_bbar_pub_ok:
    s_cmp_eq_u32 s3, 0
    s_cbranch_scc0 k4_pub1
    v_readfirstlane_b32 s56, v5
    s_nop 0
    s_cmp_eq_u32 s56, 0
    s_cbranch_scc0 kf_tagok_b
    v_mov_b32 v104, 0
    s_mov_b32 s49, 0x20000
kf_tag_b:
    global_load_dword v105, v104, s[54:55] sc1
    s_waitcnt vmcnt(0)
    v_readfirstlane_b32 s56, v105
    s_sub_u32 s49, s49, 1
    s_cmp_eq_u32 s49, 0
    s_cbranch_scc1 kf_tag_b_done
    s_cmp_eq_u32 s56, 0
    s_cbranch_scc0 kf_tag_b_done
    s_sleep 1
    s_branch kf_tag_b
kf_tag_b_done:
kf_tagok_b:
    s_lshl_b32 s36, s28, 2
    s_add_u32 s36, s36, 13395968
    v_mov_b32 v104, 0
    v_mov_b32 v105, s56
    s_mov_b64 exec, 1
    buffer_store_dword v105, v104, s[20:23], s36 offen sc1
    s_mov_b64 exec, -1
k4_pub1:
    s_setprio 0
    s_lshr_b32 s36, s19, 2
    s_lshl_b32 s36, s36, 16
    s_lshl_b32 s37, s3, 13
    s_add_u32 s36, s36, s37
    s_add_u32 s36, s36, 12779520
    v_lshlrev_b32 v104, 4, v1
    s_add_u32 s37, s36, 0
    buffer_load_dwordx4 v[8:11], v104, s[20:23], s37 offen
    s_add_u32 s37, s37, 32768
    buffer_load_dwordx4 v[40:43], v104, s[20:23], s37 offen
    s_add_u32 s37, s36, 1024
    buffer_load_dwordx4 v[12:15], v104, s[20:23], s37 offen
    s_add_u32 s37, s37, 32768
    buffer_load_dwordx4 v[44:47], v104, s[20:23], s37 offen
    s_add_u32 s37, s36, 2048
    buffer_load_dwordx4 v[16:19], v104, s[20:23], s37 offen
    s_add_u32 s37, s37, 32768
    buffer_load_dwordx4 v[48:51], v104, s[20:23], s37 offen
    s_add_u32 s37, s36, 3072
    buffer_load_dwordx4 v[20:23], v104, s[20:23], s37 offen
    s_add_u32 s37, s37, 32768
    buffer_load_dwordx4 v[52:55], v104, s[20:23], s37 offen
    s_add_u32 s37, s36, 4096
    buffer_load_dwordx4 v[24:27], v104, s[20:23], s37 offen
    s_add_u32 s37, s37, 32768
    buffer_load_dwordx4 v[56:59], v104, s[20:23], s37 offen
    s_add_u32 s37, s36, 5120
    buffer_load_dwordx4 v[28:31], v104, s[20:23], s37 offen
    s_add_u32 s37, s37, 32768
    buffer_load_dwordx4 v[60:63], v104, s[20:23], s37 offen
    s_add_u32 s37, s36, 6144
    buffer_load_dwordx4 v[32:35], v104, s[20:23], s37 offen
    s_add_u32 s37, s37, 32768
    buffer_load_dwordx4 v[64:67], v104, s[20:23], s37 offen
    s_add_u32 s37, s36, 7168
    buffer_load_dwordx4 v[36:39], v104, s[20:23], s37 offen
    s_add_u32 s37, s37, 32768
    buffer_load_dwordx4 v[68:71], v104, s[20:23], s37 offen
    s_cmp_eq_u32 s3, 0
    s_cbranch_scc0 k4_mid1
    v_lshlrev_b32 v104, 2, v1
    v_add_u32 v104, 13395968, v104
    v_add_u32 v105, 256, v104
    v_add_u32 v106, 512, v104
    v_add_u32 v107, 768, v104
    s_mov_b32 s49, 0x20000
poll_p2b:
    buffer_load_dword v108, v104, s[20:23], 0 offen sc1
    buffer_load_dword v109, v105, s[20:23], 0 offen sc1
    buffer_load_dword v110, v106, s[20:23], 0 offen sc1
    buffer_load_dword v111, v107, s[20:23], 0 offen sc1
    s_waitcnt vmcnt(0)
    v_cmp_eq_u32 vcc, s56, v108
    v_cmp_eq_u32 s[50:51], s56, v109
    s_nop 1
    s_and_b64 vcc, vcc, s[50:51]
    v_cmp_eq_u32 s[50:51], s56, v110
    s_nop 1
    s_and_b64 vcc, vcc, s[50:51]
    v_cmp_eq_u32 s[50:51], s56, v111
    s_nop 1
    s_and_b64 vcc, vcc, s[50:51]
    s_nop 1
    s_cmp_eq_u64 vcc, -1
    s_cbranch_scc1 poll_p2b_done
    s_sub_u32 s49, s49, 1
    s_cmp_eq_u32 s49, 0
    s_cbranch_scc1 poll_p2b_done
    s_sleep 1
    s_branch poll_p2b
poll_p2b_done:
    s_lshr_b32 s33, s19, 3
    s_lshl_b32 s33, s33, 3
    s_add_u32 s33, s33, s18
    s_and_b32 s36, s19, 7
    v_lshrrev_b32 v104, 1, v1
    v_lshlrev_b32 v104, 13, v104
    v_and_b32 v105, 1, v1
    v_lshl_add_u32 v104, v105, 4, v104
    s_lshl_b32 s33, s33, 8
    s_lshl_b32 s36, s36, 5
    s_add_u32 s33, s33, s36
    s_add_u32 s33, s33, 8585216
    s_mov_b32 m0, 139264
    s_add_u32 s36, s33, 0
    buffer_load_dwordx4 v104, s[20:23], s36 offen sc1 lds
    s_mov_b32 m0, 140288
    s_add_u32 s36, s33, 262144
    buffer_load_dwordx4 v104, s[20:23], s36 offen sc1 lds
    s_mov_b32 m0, 141312
    s_add_u32 s36, s33, 524288
    buffer_load_dwordx4 v104, s[20:23], s36 offen sc1 lds
    s_mov_b32 m0, 142336
    s_add_u32 s36, s33, 786432
    buffer_load_dwordx4 v104, s[20:23], s36 offen sc1 lds
    s_mov_b32 m0, 143360
    s_add_u32 s36, s33, 1048576
    buffer_load_dwordx4 v104, s[20:23], s36 offen sc1 lds
    s_mov_b32 m0, 144384
    s_add_u32 s36, s33, 1310720
    buffer_load_dwordx4 v104, s[20:23], s36 offen sc1 lds
    s_mov_b32 m0, 145408
    s_add_u32 s36, s33, 1572864
    buffer_load_dwordx4 v104, s[20:23], s36 offen sc1 lds
    s_mov_b32 m0, 146432
    s_add_u32 s36, s33, 1835008
    buffer_load_dwordx4 v104, s[20:23], s36 offen sc1 lds
    s_waitcnt vmcnt(0)
    v_mov_b32 v105, 163796
    v_mov_b32 v106, 1
    s_mov_b64 exec, 1
    ds_add_u32 v105, v106
    s_mov_b64 exec, -1
k4_mid1:
    v_mov_b32 v111, 163776
    v_mov_b32 v110, 1
    s_waitcnt lgkmcnt(0)
    s_mov_b64 exec, 1
    ds_add_u32 v111, v110
    s_mov_b64 exec, -1
    s_add_u32 s47, s47, 4
k2_bbar_mid:
    ds_read_b32 v109, v111
    s_waitcnt lgkmcnt(0)
    v_readfirstlane_b32 s48, v109
    s_nop 0
    s_cmp_ge_u32 s48, s47
    s_cbranch_scc1 k2_bbar_mid_ok
    s_sleep 1
    s_branch k2_bbar_mid
k2_bbar_mid_ok:
    v_lshlrev_b32 v2, 4, v1
    s_lshl_b32 s28, s18, 2
    s_and_b32 s29, s19, 3
    s_add_u32 s28, s28, s29
    s_lshr_b32 s29, s19, 2
    s_lshl_b32 s30, s28, 16
    s_lshl_b32 s31, s3, 13
    s_add_u32 s30, s30, s31
    s_add_u32 s30, s30, 10682368
    v_and_b32 v0, 31, v1
    v_lshrrev_b32 v4, 5, v1
    v_mul_u32_u24 v0, 272, v0
    v_lshl_add_u32 v0, v4, 4, v0
    s_mul_i32 s33, s3, 17408
    v_add_u32 v0, s33, v0
    v_lshrrev_b32 v4, 3, v1
    v_and_b32 v5, 7, v1
    s_lshl_b32 s33, s3, 4
    v_add_u32 v6, s33, v4
    v_mul_u32_u24 v7, 272, v6
    v_lshl_add_u32 v7, v5, 5, v7
    s_lshl_b32 s33, s28, 6
    v_add_u32 v6, s33, v6
    v_lshlrev_b32 v6, 11, v6
    v_lshl_add_u32 v6, v5, 4, v6
    s_lshl_b32 s35, s29, 7
    v_and_b32 v3, 7, v1
    v_lshlrev_b32 v3, 10, v3
    v_bfe_u32 v4, v1, 3, 1
    v_lshl_add_u32 v3, v4, 15, v3
    v_add_u32 v3, 1020, v3
    s_mov_b32 s49, 0x40000
    s_mov_b32 s24, s52
    s_and_b32 s25, s53, 0xffff
    s_mov_b32 s26, 4194304
    s_mov_b32 s27, 0x20000
    v_mov_b32 v5, v3
    v_mov_b32 v3, 163800
k4_cw9:
    ds_read_b32 v4, v3
    s_waitcnt lgkmcnt(0)
    v_readfirstlane_b32 s48, v4
    s_nop 0
    s_cmp_ge_u32 s48, 8
    s_cbranch_scc1 k4_cw9_ok
    s_sleep 2
    s_branch k4_cw9
k4_cw9_ok:
    v_mov_b32 v3, v5
k4_pre:
    buffer_load_dword v4, v3, s[20:23], s30 offen sc1
    s_waitcnt vmcnt(0)
    v_cmp_eq_u32 vcc, -1, v4
    s_nop 1
    s_cmp_eq_u64 vcc, 0
    s_cbranch_scc1 k4_pre_ok
    s_sub_u32 s49, s49, 1
    s_cmp_eq_u32 s49, 0
    s_cbranch_scc1 k4_pre_ok
    s_sleep 1
    s_branch k4_pre
k4_pre_ok:
    s_setprio 3
    s_mov_b32 s49, 0x20000
k4_opoll:
    s_add_u32 s34, s30, 0
    buffer_load_dwordx4 v[72:75], v2, s[20:23], s34 offen sc1
    s_add_u32 s34, s34, 32768
    buffer_load_dwordx4 v[76:79], v2, s[20:23], s34 offen sc1
    s_add_u32 s34, s30, 1024
    buffer_load_dwordx4 v[80:83], v2, s[20:23], s34 offen sc1
    s_add_u32 s34, s34, 32768
    buffer_load_dwordx4 v[84:87], v2, s[20:23], s34 offen sc1
    s_add_u32 s34, s30, 2048
    buffer_load_dwordx4 v[88:91], v2, s[20:23], s34 offen sc1
    s_add_u32 s34, s34, 32768
    buffer_load_dwordx4 v[92:95], v2, s[20:23], s34 offen sc1
    s_add_u32 s34, s30, 3072
    buffer_load_dwordx4 v[96:99], v2, s[20:23], s34 offen sc1
    s_add_u32 s34, s34, 32768
    buffer_load_dwordx4 v[100:103], v2, s[20:23], s34 offen sc1
    s_add_u32 s34, s30, 4096
    buffer_load_dwordx4 v[104:107], v2, s[20:23], s34 offen sc1
    s_add_u32 s34, s34, 32768
    buffer_load_dwordx4 v[108:111], v2, s[20:23], s34 offen sc1
    s_add_u32 s34, s30, 5120
    buffer_load_dwordx4 v[112:115], v2, s[20:23], s34 offen sc1
    s_add_u32 s34, s34, 32768
    buffer_load_dwordx4 v[116:119], v2, s[20:23], s34 offen sc1
    s_add_u32 s34, s30, 6144
    buffer_load_dwordx4 v[120:123], v2, s[20:23], s34 offen sc1
    s_add_u32 s34, s34, 32768
    buffer_load_dwordx4 v[124:127], v2, s[20:23], s34 offen sc1
    s_add_u32 s34, s30, 7168
    buffer_load_dwordx4 v[128:131], v2, s[20:23], s34 offen sc1
    s_add_u32 s34, s34, 32768
    buffer_load_dwordx4 v[132:135], v2, s[20:23], s34 offen sc1
    s_waitcnt vmcnt(14)
    v_mfma_f32_32x32x16_bf16 v[136:151], v[8:11], v[72:75], 0
    v_mfma_f32_32x32x16_bf16 v[152:167], v[8:11], v[76:79], 0
    v_max3_u32 v3, v72, v73, v74
    v_max3_u32 v3, v3, v75, v76
    v_max3_u32 v3, v3, v77, v78
    v_max_u32 v3, v3, v79
    s_waitcnt vmcnt(12)
    v_mfma_f32_32x32x16_bf16 v[136:151], v[12:15], v[80:83], v[136:151]
    v_mfma_f32_32x32x16_bf16 v[152:167], v[12:15], v[84:87], v[152:167]
    v_max3_u32 v3, v3, v80, v81
    v_max3_u32 v3, v3, v82, v83
    v_max3_u32 v3, v3, v84, v85
    v_max3_u32 v3, v3, v86, v87
    s_waitcnt vmcnt(10)
    v_mfma_f32_32x32x16_bf16 v[136:151], v[16:19], v[88:91], v[136:151]
    v_mfma_f32_32x32x16_bf16 v[152:167], v[16:19], v[92:95], v[152:167]
    v_max3_u32 v3, v3, v88, v89
    v_max3_u32 v3, v3, v90, v91
    v_max3_u32 v3, v3, v92, v93
    v_max3_u32 v3, v3, v94, v95
    s_waitcnt vmcnt(8)
    v_mfma_f32_32x32x16_bf16 v[136:151], v[20:23], v[96:99], v[136:151]
    v_mfma_f32_32x32x16_bf16 v[152:167], v[20:23], v[100:103], v[152:167]
    v_max3_u32 v3, v3, v96, v97
    v_max3_u32 v3, v3, v98, v99
    v_max3_u32 v3, v3, v100, v101
    v_max3_u32 v3, v3, v102, v103
    s_waitcnt vmcnt(6)
    v_mfma_f32_32x32x16_bf16 v[136:151], v[24:27], v[104:107], v[136:151]
    v_mfma_f32_32x32x16_bf16 v[152:167], v[24:27], v[108:111], v[152:167]
    v_max3_u32 v3, v3, v104, v105
    v_max3_u32 v3, v3, v106, v107
    v_max3_u32 v3, v3, v108, v109
    v_max3_u32 v3, v3, v110, v111
    s_waitcnt vmcnt(4)
    v_mfma_f32_32x32x16_bf16 v[136:151], v[28:31], v[112:115], v[136:151]
    v_mfma_f32_32x32x16_bf16 v[152:167], v[28:31], v[116:119], v[152:167]
    v_max3_u32 v3, v3, v112, v113
    v_max3_u32 v3, v3, v114, v115
    v_max3_u32 v3, v3, v116, v117
    v_max3_u32 v3, v3, v118, v119
    s_waitcnt vmcnt(2)
    v_mfma_f32_32x32x16_bf16 v[136:151], v[32:35], v[120:123], v[136:151]
    v_mfma_f32_32x32x16_bf16 v[152:167], v[32:35], v[124:127], v[152:167]
    v_max3_u32 v3, v3, v120, v121
    v_max3_u32 v3, v3, v122, v123
    v_max3_u32 v3, v3, v124, v125
    v_max3_u32 v3, v3, v126, v127
    s_waitcnt vmcnt(0)
    v_mfma_f32_32x32x16_bf16 v[136:151], v[36:39], v[128:131], v[136:151]
    v_mfma_f32_32x32x16_bf16 v[152:167], v[36:39], v[132:135], v[152:167]
    v_max3_u32 v3, v3, v128, v129
    v_max3_u32 v3, v3, v130, v131
    v_max3_u32 v3, v3, v132, v133
    v_max3_u32 v3, v3, v134, v135
    v_cmp_eq_u32 vcc, -1, v3
    s_nop 1
    s_cmp_eq_u64 vcc, 0
    s_cbranch_scc1 k4_ook
    s_sub_u32 s49, s49, 1
    s_cmp_eq_u32 s49, 0
    s_cbranch_scc1 k4_ook
    s_nop 15
    s_sleep 2
    s_branch k4_opoll
k4_ook:
    v_mfma_f32_32x32x16_bf16 v[8:23], v[40:43], v[72:75], 0
    v_mfma_f32_32x32x16_bf16 v[24:39], v[40:43], v[76:79], 0
    v_mfma_f32_32x32x16_bf16 v[8:23], v[44:47], v[80:83], v[8:23]
    v_mfma_f32_32x32x16_bf16 v[24:39], v[44:47], v[84:87], v[24:39]
    v_mfma_f32_32x32x16_bf16 v[8:23], v[48:51], v[88:91], v[8:23]
    v_mfma_f32_32x32x16_bf16 v[24:39], v[48:51], v[92:95], v[24:39]
    ds_write_b128 v0, v[136:139] offset:0
    ds_write_b128 v0, v[140:143] offset:32
    v_mfma_f32_32x32x16_bf16 v[8:23], v[52:55], v[96:99], v[8:23]
    v_mfma_f32_32x32x16_bf16 v[24:39], v[52:55], v[100:103], v[24:39]
    ds_write_b128 v0, v[144:147] offset:64
    ds_write_b128 v0, v[148:151] offset:96
    v_mfma_f32_32x32x16_bf16 v[8:23], v[56:59], v[104:107], v[8:23]
    v_mfma_f32_32x32x16_bf16 v[24:39], v[56:59], v[108:111], v[24:39]
    ds_write_b128 v0, v[152:155] offset:8704
    ds_write_b128 v0, v[156:159] offset:8736
    v_mfma_f32_32x32x16_bf16 v[8:23], v[60:63], v[112:115], v[8:23]
    v_mfma_f32_32x32x16_bf16 v[24:39], v[60:63], v[116:119], v[24:39]
    ds_write_b128 v0, v[160:163] offset:8768
    ds_write_b128 v0, v[164:167] offset:8800
    v_mfma_f32_32x32x16_bf16 v[8:23], v[64:67], v[120:123], v[8:23]
    v_mfma_f32_32x32x16_bf16 v[24:39], v[64:67], v[124:127], v[24:39]
    v_mfma_f32_32x32x16_bf16 v[8:23], v[68:71], v[128:131], v[8:23]
    v_mfma_f32_32x32x16_bf16 v[24:39], v[68:71], v[132:135], v[24:39]
    s_nop 11
    ds_write_b128 v0, v[8:11] offset:128
    ds_write_b128 v0, v[12:15] offset:160
    ds_write_b128 v0, v[16:19] offset:192
    ds_write_b128 v0, v[20:23] offset:224
    ds_write_b128 v0, v[24:27] offset:8832
    ds_write_b128 v0, v[28:31] offset:8864
    ds_write_b128 v0, v[32:35] offset:8896
    ds_write_b128 v0, v[36:39] offset:8928
    s_waitcnt lgkmcnt(0)
    v_mov_b32 v3, 163784
    v_mov_b32 v4, 1
    s_mov_b64 exec, 1
    ds_add_u32 v3, v4
    s_mov_b64 exec, -1
    v_mov_b32 v3, 163784
k4_cw10:
    ds_read_b32 v4, v3
    s_waitcnt lgkmcnt(0)
    v_readfirstlane_b32 s48, v4
    s_nop 0
    s_cmp_ge_u32 s48, 4
    s_cbranch_scc1 k4_cw10_ok
    s_branch k4_cw10
k4_cw10_ok:
    ds_read_b128 v[8:11], v7 offset:0
    ds_read_b128 v[12:15], v7 offset:16
    ds_read_b128 v[16:19], v7 offset:17408
    ds_read_b128 v[20:23], v7 offset:17424
    ds_read_b128 v[24:27], v7 offset:34816
    ds_read_b128 v[28:31], v7 offset:34832
    ds_read_b128 v[32:35], v7 offset:52224
    ds_read_b128 v[36:39], v7 offset:52240
    s_waitcnt lgkmcnt(4)
    v_add_f32 v8, v8, v16
    v_add_f32 v9, v9, v17
    v_add_f32 v10, v10, v18
    v_add_f32 v11, v11, v19
    v_add_f32 v12, v12, v20
    v_add_f32 v13, v13, v21
    v_add_f32 v14, v14, v22
    v_add_f32 v15, v15, v23
    s_waitcnt lgkmcnt(0)
    v_add_f32 v24, v24, v32
    v_add_f32 v25, v25, v33
    v_add_f32 v26, v26, v34
    v_add_f32 v27, v27, v35
    v_add_f32 v28, v28, v36
    v_add_f32 v29, v29, v37
    v_add_f32 v30, v30, v38
    v_add_f32 v31, v31, v39
    v_add_f32 v8, v8, v24
    v_add_f32 v9, v9, v25
    v_add_f32 v10, v10, v26
    v_add_f32 v11, v11, v27
    v_add_f32 v12, v12, v28
    v_add_f32 v13, v13, v29
    v_add_f32 v14, v14, v30
    v_add_f32 v15, v15, v31
    v_cvt_pk_bf16_f32 v80, v8, v9
    v_cvt_pk_bf16_f32 v81, v10, v11
    v_cvt_pk_bf16_f32 v82, v12, v13
    v_cvt_pk_bf16_f32 v83, v14, v15
    s_add_u32 s36, s35, 0
    buffer_store_dwordx4 v[80:83], v6, s[24:27], s36 offen sc1
    s_endpgm
k2_b2:
    s_waitcnt vmcnt(0)
    s_cmp_eq_u32 s3, 0
    s_cbranch_scc0 k2_notagreq
    v_mov_b32 v104, 0
    global_load_dword v5, v104, s[54:55] sc1
k2_notagreq:
    v_mov_b32 v111, 163776
    v_mov_b32 v110, 1
    s_waitcnt lgkmcnt(0)
    s_mov_b64 exec, 1
    ds_add_u32 v111, v110
    s_mov_b64 exec, -1
    s_add_u32 s47, s47, 4
k2_bbar_col:
    ds_read_b32 v109, v111
    s_waitcnt lgkmcnt(0)
    v_readfirstlane_b32 s48, v109
    s_nop 0
    s_cmp_ge_u32 s48, s47
    s_cbranch_scc1 k2_bbar_col_ok
    s_sleep 1
    s_branch k2_bbar_col
k2_bbar_col_ok:
    v_and_b32 v108, 15, v1
    v_lshrrev_b32 v109, 4, v1
    v_xor_b32 v104, v108, v109
    v_lshlrev_b32 v104, 4, v104
    v_lshl_add_u32 v104, v108, 8, v104
    v_add_u32 v104, 131072, v104
    v_xor_b32 v105, 64, v104
    v_xor_b32 v106, 128, v104
    v_xor_b32 v107, 192, v104
    ds_read_b128 v[112:115], v104 offset:0
    ds_read_b128 v[128:131], v104 offset:4096
    ds_read_b128 v[116:119], v105 offset:0
    ds_read_b128 v[132:135], v105 offset:4096
    ds_read_b128 v[120:123], v106 offset:0
    ds_read_b128 v[136:139], v106 offset:4096
    ds_read_b128 v[124:127], v107 offset:0
    ds_read_b128 v[140:143], v107 offset:4096
    s_waitcnt lgkmcnt(6)
    v_mfma_f32_16x16x32_bf16 v[144:147], v[112:115], v[8:11], 0
    v_mfma_f32_16x16x32_bf16 v[148:151], v[112:115], v[12:15], 0
    v_mfma_f32_16x16x32_bf16 v[152:155], v[128:131], v[8:11], 0
    v_mfma_f32_16x16x32_bf16 v[156:159], v[128:131], v[12:15], 0
    s_waitcnt lgkmcnt(4)
    v_mfma_f32_16x16x32_bf16 v[144:147], v[116:119], v[16:19], v[144:147]
    v_mfma_f32_16x16x32_bf16 v[148:151], v[116:119], v[20:23], v[148:151]
    v_mfma_f32_16x16x32_bf16 v[152:155], v[132:135], v[16:19], v[152:155]
    v_mfma_f32_16x16x32_bf16 v[156:159], v[132:135], v[20:23], v[156:159]
    s_waitcnt lgkmcnt(2)
    v_mfma_f32_16x16x32_bf16 v[144:147], v[120:123], v[24:27], v[144:147]
    v_mfma_f32_16x16x32_bf16 v[148:151], v[120:123], v[28:31], v[148:151]
    v_mfma_f32_16x16x32_bf16 v[152:155], v[136:139], v[24:27], v[152:155]
    v_mfma_f32_16x16x32_bf16 v[156:159], v[136:139], v[28:31], v[156:159]
    s_waitcnt lgkmcnt(0)
    v_mfma_f32_16x16x32_bf16 v[144:147], v[124:127], v[32:35], v[144:147]
    v_mfma_f32_16x16x32_bf16 v[148:151], v[124:127], v[36:39], v[148:151]
    v_mfma_f32_16x16x32_bf16 v[152:155], v[140:143], v[32:35], v[152:155]
    v_mfma_f32_16x16x32_bf16 v[156:159], v[140:143], v[36:39], v[156:159]
    s_cmp_eq_u32 s28, 0
    s_cbranch_scc0 k2_p1_noab
    v_lshlrev_b32 v110, 4, v1
    s_lshl_b32 s36, s3, 12
    s_add_u32 s36, s36, 13361152
    buffer_load_dwordx4 v[128:131], v110, s[20:23], s36 offen offset:0
    buffer_load_dwordx4 v[132:135], v110, s[20:23], s36 offen offset:1024
    buffer_load_dwordx4 v[136:139], v110, s[20:23], s36 offen offset:2048
    buffer_load_dwordx4 v[140:143], v110, s[20:23], s36 offen offset:3072
k2_p1_noab:
    s_nop 6
    v_pk_mul_f32 v[104:105], v[144:145], v[72:73]
    v_pk_mul_f32 v[108:109], v[148:149], v[72:73]
    v_pk_mul_f32 v[106:107], v[146:147], v[74:75]
    v_pk_mul_f32 v[110:111], v[150:151], v[74:75]
    v_pk_fma_f32 v[104:105], v[148:149], v[80:81], v[104:105]
    v_pk_fma_f32 v[108:109], v[144:145], v[80:81], v[108:109] neg_lo:[1,0,0] neg_hi:[1,0,0]
    v_pk_fma_f32 v[106:107], v[150:151], v[82:83], v[106:107]
    v_pk_fma_f32 v[110:111], v[146:147], v[82:83], v[110:111] neg_lo:[1,0,0] neg_hi:[1,0,0]
    v_cvt_pk_bf16_f32 v96, v104, v108
    v_cvt_pk_bf16_f32 v97, v105, v109
    v_cvt_pk_bf16_f32 v98, v106, v110
    v_cvt_pk_bf16_f32 v99, v107, v111
    v_pk_mul_f32 v[104:105], v[152:153], v[76:77]
    v_pk_mul_f32 v[108:109], v[156:157], v[76:77]
    v_pk_mul_f32 v[106:107], v[154:155], v[78:79]
    v_pk_mul_f32 v[110:111], v[158:159], v[78:79]
    v_pk_fma_f32 v[104:105], v[156:157], v[84:85], v[104:105]
    v_pk_fma_f32 v[108:109], v[152:153], v[84:85], v[108:109] neg_lo:[1,0,0] neg_hi:[1,0,0]
    v_pk_fma_f32 v[106:107], v[158:159], v[86:87], v[106:107]
    v_pk_fma_f32 v[110:111], v[154:155], v[86:87], v[110:111] neg_lo:[1,0,0] neg_hi:[1,0,0]
    v_cvt_pk_bf16_f32 v100, v104, v108
    v_cvt_pk_bf16_f32 v101, v105, v109
    v_cvt_pk_bf16_f32 v102, v106, v110
    v_cvt_pk_bf16_f32 v103, v107, v111
    s_nop 1
    v_mfma_f32_16x16x32_bf16 v[112:115], v[40:43], v[96:99], 0
    v_mfma_f32_16x16x32_bf16 v[116:119], v[48:51], v[96:99], 0
    v_mfma_f32_16x16x32_bf16 v[120:123], v[56:59], v[96:99], 0
    v_mfma_f32_16x16x32_bf16 v[124:127], v[64:67], v[96:99], 0
    v_mfma_f32_16x16x32_bf16 v[112:115], v[44:47], v[100:103], v[112:115]
    v_mfma_f32_16x16x32_bf16 v[116:119], v[52:55], v[100:103], v[116:119]
    v_mfma_f32_16x16x32_bf16 v[120:123], v[60:63], v[100:103], v[120:123]
    v_mfma_f32_16x16x32_bf16 v[124:127], v[68:71], v[100:103], v[124:127]
    s_waitcnt vmcnt(0)
    s_cmp_eq_u32 s28, 0
    s_cbranch_scc1 k2_p2_special
    v_lshlrev_b32 v144, 16, v88
    v_and_b32 v148, 0xffff0000, v88
    v_lshlrev_b32 v145, 16, v89
    v_and_b32 v149, 0xffff0000, v89
    v_lshlrev_b32 v146, 16, v90
    v_and_b32 v150, 0xffff0000, v90
    v_lshlrev_b32 v147, 16, v91
    v_and_b32 v151, 0xffff0000, v91
    v_pk_mul_f32 v[104:105], v[112:113], v[144:145]
    v_pk_mul_f32 v[108:109], v[112:113], v[148:149]
    v_pk_mul_f32 v[106:107], v[114:115], v[146:147]
    v_pk_mul_f32 v[110:111], v[114:115], v[150:151]
    v_pk_fma_f32 v[104:105], v[116:117], v[148:149], v[104:105] neg_lo:[1,0,0] neg_hi:[1,0,0]
    v_pk_fma_f32 v[108:109], v[116:117], v[144:145], v[108:109]
    v_pk_fma_f32 v[106:107], v[118:119], v[150:151], v[106:107] neg_lo:[1,0,0] neg_hi:[1,0,0]
    v_pk_fma_f32 v[110:111], v[118:119], v[146:147], v[110:111]
    v_cvt_pk_bf16_f32 v96, v104, -v108
    v_cvt_pk_bf16_f32 v97, v105, -v109
    v_cvt_pk_bf16_f32 v98, v106, -v110
    v_cvt_pk_bf16_f32 v99, v107, -v111
    v_lshlrev_b32 v152, 16, v92
    v_and_b32 v156, 0xffff0000, v92
    v_lshlrev_b32 v153, 16, v93
    v_and_b32 v157, 0xffff0000, v93
    v_lshlrev_b32 v154, 16, v94
    v_and_b32 v158, 0xffff0000, v94
    v_lshlrev_b32 v155, 16, v95
    v_and_b32 v159, 0xffff0000, v95
    v_pk_mul_f32 v[104:105], v[120:121], v[152:153]
    v_pk_mul_f32 v[108:109], v[120:121], v[156:157]
    v_pk_mul_f32 v[106:107], v[122:123], v[154:155]
    v_pk_mul_f32 v[110:111], v[122:123], v[158:159]
    v_pk_fma_f32 v[104:105], v[124:125], v[156:157], v[104:105] neg_lo:[1,0,0] neg_hi:[1,0,0]
    v_pk_fma_f32 v[108:109], v[124:125], v[152:153], v[108:109]
    v_pk_fma_f32 v[106:107], v[126:127], v[158:159], v[106:107] neg_lo:[1,0,0] neg_hi:[1,0,0]
    v_pk_fma_f32 v[110:111], v[126:127], v[154:155], v[110:111]
    v_cvt_pk_bf16_f32 v100, v104, -v108
    v_cvt_pk_bf16_f32 v101, v105, -v109
    v_cvt_pk_bf16_f32 v102, v106, -v110
    v_cvt_pk_bf16_f32 v103, v107, -v111
k2_p2_common:
    s_nop 1
    v_mfma_f32_16x16x32_bf16 v[144:147], v[40:43], v[96:99], 0
    v_mfma_f32_16x16x32_bf16 v[148:151], v[48:51], v[96:99], 0
    v_mfma_f32_16x16x32_bf16 v[152:155], v[56:59], v[96:99], 0
    v_mfma_f32_16x16x32_bf16 v[156:159], v[64:67], v[96:99], 0
    v_mfma_f32_16x16x32_bf16 v[144:147], v[44:47], v[100:103], v[144:147]
    v_mfma_f32_16x16x32_bf16 v[148:151], v[52:55], v[100:103], v[148:151]
    v_mfma_f32_16x16x32_bf16 v[152:155], v[60:63], v[100:103], v[152:155]
    v_mfma_f32_16x16x32_bf16 v[156:159], v[68:71], v[100:103], v[156:159]
    v_and_b32 v112, 15, v1
    v_lshrrev_b32 v113, 4, v1
    v_lshrrev_b32 v114, 2, v112
    s_lshl_b32 s36, s3, 2
    v_add_u32 v114, s36, v114
    v_lshlrev_b32 v115, 2, v113
    v_xor_b32 v114, v114, v115
    v_lshlrev_b32 v114, 4, v114
    v_lshl_add_u32 v114, v115, 8, v114
    v_and_b32 v116, 3, v112
    v_lshl_add_u32 v114, v116, 2, v114
    v_add_u32 v120, 139264, v114
    v_xor_b32 v121, 16, v120
    v_xor_b32 v122, 32, v120
    v_xor_b32 v123, 48, v120
    v_pk_mul_f32 v[104:105], v[144:145], v[72:73]
    v_pk_mul_f32 v[108:109], v[148:149], v[72:73]
    v_pk_mul_f32 v[106:107], v[146:147], v[74:75]
    v_pk_mul_f32 v[110:111], v[150:151], v[74:75]
    v_pk_fma_f32 v[104:105], v[148:149], v[80:81], v[104:105]
    v_pk_fma_f32 v[108:109], v[144:145], v[80:81], v[108:109] neg_lo:[1,0,0] neg_hi:[1,0,0]
    v_pk_fma_f32 v[106:107], v[150:151], v[82:83], v[106:107]
    v_pk_fma_f32 v[110:111], v[146:147], v[82:83], v[110:111] neg_lo:[1,0,0] neg_hi:[1,0,0]
    v_cvt_pk_bf16_f32 v96, v104, v108
    v_cvt_pk_bf16_f32 v97, v105, v109
    v_cvt_pk_bf16_f32 v98, v106, v110
    v_cvt_pk_bf16_f32 v99, v107, v111
    v_pk_mul_f32 v[104:105], v[152:153], v[76:77]
    v_pk_mul_f32 v[108:109], v[156:157], v[76:77]
    v_pk_mul_f32 v[106:107], v[154:155], v[78:79]
    v_pk_mul_f32 v[110:111], v[158:159], v[78:79]
    v_pk_fma_f32 v[104:105], v[156:157], v[84:85], v[104:105]
    v_pk_fma_f32 v[108:109], v[152:153], v[84:85], v[108:109] neg_lo:[1,0,0] neg_hi:[1,0,0]
    v_pk_fma_f32 v[106:107], v[158:159], v[86:87], v[106:107]
    v_pk_fma_f32 v[110:111], v[154:155], v[86:87], v[110:111] neg_lo:[1,0,0] neg_hi:[1,0,0]
    v_cvt_pk_bf16_f32 v100, v104, v108
    v_cvt_pk_bf16_f32 v101, v105, v109
    v_cvt_pk_bf16_f32 v102, v106, v110
    v_cvt_pk_bf16_f32 v103, v107, v111
    ds_write_b32 v120, v96 offset:0
    ds_write_b32 v121, v97 offset:256
    ds_write_b32 v122, v98 offset:512
    ds_write_b32 v123, v99 offset:768
    ds_write_b32 v120, v100 offset:4096
    ds_write_b32 v121, v101 offset:4352
    ds_write_b32 v122, v102 offset:4608
    ds_write_b32 v123, v103 offset:4864
    v_mov_b32 v111, 163776
    v_mov_b32 v110, 1
    s_waitcnt lgkmcnt(0)
    s_mov_b64 exec, 1
    ds_add_u32 v111, v110
    s_mov_b64 exec, -1
    s_add_u32 s47, s47, 4
k2_bbar_e:
    ds_read_b32 v109, v111
    s_waitcnt lgkmcnt(0)
    v_readfirstlane_b32 s48, v109
    s_nop 0
    s_cmp_ge_u32 s48, s47
    s_cbranch_scc1 k2_bbar_e_ok
    s_sleep 1
    s_branch k2_bbar_e
k2_bbar_e_ok:
    v_and_b32 v108, 15, v1
    v_lshrrev_b32 v109, 4, v1
    v_xor_b32 v104, v108, v109
    v_lshlrev_b32 v104, 4, v104
    v_lshl_add_u32 v104, v108, 8, v104
    v_add_u32 v104, 139264, v104
    v_xor_b32 v105, 64, v104
    v_xor_b32 v106, 128, v104
    v_xor_b32 v107, 192, v104
    ds_read_b128 v[112:115], v104 offset:0
    ds_read_b128 v[128:131], v104 offset:4096
    ds_read_b128 v[116:119], v105 offset:0
    ds_read_b128 v[132:135], v105 offset:4096
    ds_read_b128 v[120:123], v106 offset:0
    ds_read_b128 v[136:139], v106 offset:4096
    ds_read_b128 v[124:127], v107 offset:0
    ds_read_b128 v[140:143], v107 offset:4096
    v_lshlrev_b32 v110, 8, v108
    v_lshl_add_u32 v110, v109, 4, v110
    s_lshl_b32 s36, s28, 13
    s_lshl_b32 s37, s3, 6
    s_add_u32 s36, s36, s37
    s_add_u32 s36, s36, 8585216
    s_waitcnt lgkmcnt(6)
    v_mfma_f32_16x16x32_bf16 v[144:147], v[8:11], v[112:115], 0
    v_mfma_f32_16x16x32_bf16 v[148:151], v[12:15], v[112:115], 0
    v_mfma_f32_16x16x32_bf16 v[152:155], v[8:11], v[128:131], 0
    v_mfma_f32_16x16x32_bf16 v[156:159], v[12:15], v[128:131], 0
    s_waitcnt lgkmcnt(4)
    v_mfma_f32_16x16x32_bf16 v[144:147], v[16:19], v[116:119], v[144:147]
    v_mfma_f32_16x16x32_bf16 v[148:151], v[20:23], v[116:119], v[148:151]
    v_mfma_f32_16x16x32_bf16 v[152:155], v[16:19], v[132:135], v[152:155]
    v_mfma_f32_16x16x32_bf16 v[156:159], v[20:23], v[132:135], v[156:159]
    s_waitcnt lgkmcnt(2)
    v_mfma_f32_16x16x32_bf16 v[144:147], v[24:27], v[120:123], v[144:147]
    v_mfma_f32_16x16x32_bf16 v[148:151], v[28:31], v[120:123], v[148:151]
    v_mfma_f32_16x16x32_bf16 v[152:155], v[24:27], v[136:139], v[152:155]
    v_mfma_f32_16x16x32_bf16 v[156:159], v[28:31], v[136:139], v[156:159]
    s_waitcnt lgkmcnt(0)
    v_mfma_f32_16x16x32_bf16 v[144:147], v[32:35], v[124:127], v[144:147]
    v_mfma_f32_16x16x32_bf16 v[148:151], v[36:39], v[124:127], v[148:151]
    v_mfma_f32_16x16x32_bf16 v[152:155], v[32:35], v[140:143], v[152:155]
    v_mfma_f32_16x16x32_bf16 v[156:159], v[36:39], v[140:143], v[156:159]
    s_nop 7
    v_cvt_pk_bf16_f32 v96, v144, -v148
    v_cvt_pk_bf16_f32 v97, v145, -v149
    v_cvt_pk_bf16_f32 v98, v146, -v150
    v_cvt_pk_bf16_f32 v99, v147, -v151
    buffer_store_dwordx4 v[96:99], v110, s[20:23], s36 offen sc1
    s_add_u32 s36, s36, 4096
    v_cvt_pk_bf16_f32 v100, v152, -v156
    v_cvt_pk_bf16_f32 v101, v153, -v157
    v_cvt_pk_bf16_f32 v102, v154, -v158
    v_cvt_pk_bf16_f32 v103, v155, -v159
    buffer_store_dwordx4 v[100:103], v110, s[20:23], s36 offen sc1
    s_setpc_b64 s[60:61]
k2_p2_special:
    v_mov_b32 v111, 163776
    v_mov_b32 v110, 1
    s_waitcnt lgkmcnt(0)
    s_mov_b64 exec, 1
    ds_add_u32 v111, v110
    s_mov_b64 exec, -1
    s_add_u32 s47, s47, 4
k2_bbar_s0:
    ds_read_b32 v109, v111
    s_waitcnt lgkmcnt(0)
    v_readfirstlane_b32 s48, v109
    s_nop 0
    s_cmp_ge_u32 s48, s47
    s_cbranch_scc1 k2_bbar_s0_ok
    s_sleep 1
    s_branch k2_bbar_s0
k2_bbar_s0_ok:
    v_and_b32 v104, 15, v1
    v_lshrrev_b32 v105, 4, v1
    s_lshl_b32 s36, s3, 4
    v_add_u32 v104, s36, v104
    v_lshl_add_u32 v104, v105, 8, v104
    v_lshlrev_b32 v106, 3, v104
    v_add_u32 v106, 131072, v106
    ds_write_b32 v106, v112 offset:0
    ds_write_b32 v106, v116 offset:4
    ds_write_b32 v106, v113 offset:512
    ds_write_b32 v106, v117 offset:516
    ds_write_b32 v106, v114 offset:1024
    ds_write_b32 v106, v118 offset:1028
    ds_write_b32 v106, v115 offset:1536
    ds_write_b32 v106, v119 offset:1540
    ds_write_b32 v106, v120 offset:8192
    ds_write_b32 v106, v124 offset:8196
    ds_write_b32 v106, v121 offset:8704
    ds_write_b32 v106, v125 offset:8708
    ds_write_b32 v106, v122 offset:9216
    ds_write_b32 v106, v126 offset:9220
    ds_write_b32 v106, v123 offset:9728
    ds_write_b32 v106, v127 offset:9732
    v_mov_b32 v111, 163776
    v_mov_b32 v110, 1
    s_waitcnt lgkmcnt(0)
    s_mov_b64 exec, 1
    ds_add_u32 v111, v110
    s_mov_b64 exec, -1
    s_add_u32 s47, s47, 4
k2_bbar_s1:
    ds_read_b32 v109, v111
    s_waitcnt lgkmcnt(0)
    v_readfirstlane_b32 s48, v109
    s_nop 0
    s_cmp_ge_u32 s48, s47
    s_cbranch_scc1 k2_bbar_s1_ok
    s_sleep 1
    s_branch k2_bbar_s1
k2_bbar_s1_ok:
    v_sub_u32 v107, 2048, v104
    v_and_b32 v107, 2047, v107
    v_lshlrev_b32 v107, 3, v107
    v_add_u32 v107, 131072, v107
    ds_read_b64 v[144:145], v107
    v_sub_u32 v107, 1984, v104
    v_and_b32 v107, 2047, v107
    v_lshlrev_b32 v107, 3, v107
    v_add_u32 v107, 131072, v107
    ds_read_b64 v[146:147], v107
    v_sub_u32 v107, 1920, v104
    v_and_b32 v107, 2047, v107
    v_lshlrev_b32 v107, 3, v107
    v_add_u32 v107, 131072, v107
    ds_read_b64 v[148:149], v107
    v_sub_u32 v107, 1856, v104
    v_and_b32 v107, 2047, v107
    v_lshlrev_b32 v107, 3, v107
    v_add_u32 v107, 131072, v107
    ds_read_b64 v[150:151], v107
    v_sub_u32 v107, 1024, v104
    v_and_b32 v107, 2047, v107
    v_lshlrev_b32 v107, 3, v107
    v_add_u32 v107, 131072, v107
    ds_read_b64 v[152:153], v107
    v_sub_u32 v107, 960, v104
    v_and_b32 v107, 2047, v107
    v_lshlrev_b32 v107, 3, v107
    v_add_u32 v107, 131072, v107
    ds_read_b64 v[154:155], v107
    v_sub_u32 v107, 896, v104
    v_and_b32 v107, 2047, v107
    v_lshlrev_b32 v107, 3, v107
    v_add_u32 v107, 131072, v107
    ds_read_b64 v[156:157], v107
    v_sub_u32 v107, 832, v104
    v_and_b32 v107, 2047, v107
    v_lshlrev_b32 v107, 3, v107
    v_add_u32 v107, 131072, v107
    ds_read_b64 v[158:159], v107
    v_mov_b32 v111, 163776
    v_mov_b32 v110, 1
    s_waitcnt lgkmcnt(0)
    s_mov_b64 exec, 1
    ds_add_u32 v111, v110
    s_mov_b64 exec, -1
    s_add_u32 s47, s47, 4
k2_bbar_s2:
    ds_read_b32 v109, v111
    s_waitcnt lgkmcnt(0)
    v_readfirstlane_b32 s48, v109
    s_nop 0
    s_cmp_ge_u32 s48, s47
    s_cbranch_scc1 k2_bbar_s2_ok
    s_sleep 1
    s_branch k2_bbar_s2
k2_bbar_s2_ok:
    v_lshlrev_b32 v88, 16, v128
    v_and_b32 v89, 0xffff0000, v128
    v_lshlrev_b32 v90, 16, v129
    v_and_b32 v91, 0xffff0000, v129
    v_mul_f32 v104, v112, v88
    v_mul_f32 v105, v112, v89
    v_fma_f32 v104, -v116, v89, v104
    v_fma_f32 v105, v116, v88, v105
    v_fma_f32 v104, v144, v90, v104
    v_fma_f32 v105, v144, v91, v105
    v_fma_f32 v104, v145, v91, v104
    v_fma_f32 v105, -v145, v90, v105
    v_cvt_pk_bf16_f32 v96, v104, -v105
    v_lshlrev_b32 v88, 16, v130
    v_and_b32 v89, 0xffff0000, v130
    v_lshlrev_b32 v90, 16, v131
    v_and_b32 v91, 0xffff0000, v131
    v_mul_f32 v104, v113, v88
    v_mul_f32 v105, v113, v89
    v_fma_f32 v104, -v117, v89, v104
    v_fma_f32 v105, v117, v88, v105
    v_fma_f32 v104, v146, v90, v104
    v_fma_f32 v105, v146, v91, v105
    v_fma_f32 v104, v147, v91, v104
    v_fma_f32 v105, -v147, v90, v105
    v_cvt_pk_bf16_f32 v97, v104, -v105
    v_lshlrev_b32 v88, 16, v132
    v_and_b32 v89, 0xffff0000, v132
    v_lshlrev_b32 v90, 16, v133
    v_and_b32 v91, 0xffff0000, v133
    v_mul_f32 v104, v114, v88
    v_mul_f32 v105, v114, v89
    v_fma_f32 v104, -v118, v89, v104
    v_fma_f32 v105, v118, v88, v105
    v_fma_f32 v104, v148, v90, v104
    v_fma_f32 v105, v148, v91, v105
    v_fma_f32 v104, v149, v91, v104
    v_fma_f32 v105, -v149, v90, v105
    v_cvt_pk_bf16_f32 v98, v104, -v105
    v_lshlrev_b32 v88, 16, v134
    v_and_b32 v89, 0xffff0000, v134
    v_lshlrev_b32 v90, 16, v135
    v_and_b32 v91, 0xffff0000, v135
    v_mul_f32 v104, v115, v88
    v_mul_f32 v105, v115, v89
    v_fma_f32 v104, -v119, v89, v104
    v_fma_f32 v105, v119, v88, v105
    v_fma_f32 v104, v150, v90, v104
    v_fma_f32 v105, v150, v91, v105
    v_fma_f32 v104, v151, v91, v104
    v_fma_f32 v105, -v151, v90, v105
    v_cvt_pk_bf16_f32 v99, v104, -v105
    v_lshlrev_b32 v88, 16, v136
    v_and_b32 v89, 0xffff0000, v136
    v_lshlrev_b32 v90, 16, v137
    v_and_b32 v91, 0xffff0000, v137
    v_mul_f32 v104, v120, v88
    v_mul_f32 v105, v120, v89
    v_fma_f32 v104, -v124, v89, v104
    v_fma_f32 v105, v124, v88, v105
    v_fma_f32 v104, v152, v90, v104
    v_fma_f32 v105, v152, v91, v105
    v_fma_f32 v104, v153, v91, v104
    v_fma_f32 v105, -v153, v90, v105
    v_cvt_pk_bf16_f32 v100, v104, -v105
    v_lshlrev_b32 v88, 16, v138
    v_and_b32 v89, 0xffff0000, v138
    v_lshlrev_b32 v90, 16, v139
    v_and_b32 v91, 0xffff0000, v139
    v_mul_f32 v104, v121, v88
    v_mul_f32 v105, v121, v89
    v_fma_f32 v104, -v125, v89, v104
    v_fma_f32 v105, v125, v88, v105
    v_fma_f32 v104, v154, v90, v104
    v_fma_f32 v105, v154, v91, v105
    v_fma_f32 v104, v155, v91, v104
    v_fma_f32 v105, -v155, v90, v105
    v_cvt_pk_bf16_f32 v101, v104, -v105
    v_lshlrev_b32 v88, 16, v140
    v_and_b32 v89, 0xffff0000, v140
    v_lshlrev_b32 v90, 16, v141
    v_and_b32 v91, 0xffff0000, v141
    v_mul_f32 v104, v122, v88
    v_mul_f32 v105, v122, v89
    v_fma_f32 v104, -v126, v89, v104
    v_fma_f32 v105, v126, v88, v105
    v_fma_f32 v104, v156, v90, v104
    v_fma_f32 v105, v156, v91, v105
    v_fma_f32 v104, v157, v91, v104
    v_fma_f32 v105, -v157, v90, v105
    v_cvt_pk_bf16_f32 v102, v104, -v105
    v_lshlrev_b32 v88, 16, v142
    v_and_b32 v89, 0xffff0000, v142
    v_lshlrev_b32 v90, 16, v143
    v_and_b32 v91, 0xffff0000, v143
    v_mul_f32 v104, v123, v88
    v_mul_f32 v105, v123, v89
    v_fma_f32 v104, -v127, v89, v104
    v_fma_f32 v105, v127, v88, v105
    v_fma_f32 v104, v158, v90, v104
    v_fma_f32 v105, v158, v91, v105
    v_fma_f32 v104, v159, v91, v104
    v_fma_f32 v105, -v159, v90, v105
    v_cvt_pk_bf16_f32 v103, v104, -v105
    s_branch k2_p2_common
k2_end:
    s_endpgm

.section .rodata,"a"
.p2align 6
.amdhsa_kernel attn_proj_kernel
  .amdhsa_next_free_vgpr 168
  .amdhsa_next_free_sgpr 102
  .amdhsa_accum_offset 168
  .amdhsa_group_segment_fixed_size 0
  .amdhsa_kernarg_size 72
  .amdhsa_user_sgpr_count 2
  .amdhsa_user_sgpr_kernarg_segment_ptr 1
  .amdhsa_system_sgpr_workgroup_id_x 1
.end_amdhsa_kernel
```
